```python
import torch

def _softmax(x, axis=-1):
    return torch.softmax(x, dim=axis)
def _gelu(x):
    return torch.nn.functional.gelu(x, approximate="tanh")
def _silu(x):
    return torch.nn.functional.silu(x)
def _sigmoid(x):
    return torch.sigmoid(x)
def _layernorm(x, axis=-1, eps=1e-5):
    m = x.mean(dim=axis, keepdim=True)
    v = x.var(dim=axis, keepdim=True, unbiased=False)
    return (x - m) / torch.sqrt(v + eps)
def _scatter_add(tgt, idx, src, axis=0):
    return tgt.clone().index_add_(axis, idx, src)
def _segment_sum(src, seg, n):
    out = torch.zeros((n,) + src.shape[1:], dtype=src.dtype)
    return out.index_add_(0, seg, src)
def _pad(x, pw):
    flat = tuple(v for pair in reversed(pw) for v in pair)
    return torch.nn.functional.pad(x, flat)

kernel_name = 'concat_heads__gqa_block_cached__mha_block_cached__near_ridge'

def setup_inputs():

    _w = (lambda a: (lambda t: t.to(torch.bfloat16) if t.is_floating_point() else t)(torch.as_tensor(a)))
    def _A_setup():
        B, Sq, D = 16, 32, 512
        Hq, Hkv, Sk, Dh = 32, 8, 32, 128
        assert Hq % Hkv == 0, (Hq, Hkv)
        return {
            "x": _w((lambda *s: torch.randn(*s, dtype=torch.bfloat16) * 0.8)(B, Sq, D)),
            "k_cache": _w((lambda *s: torch.randn(*s, dtype=torch.bfloat16) * 0.8)(B, Hkv, Sk, Dh)),
            "v_cache": _w((lambda *s: torch.randn(*s, dtype=torch.bfloat16) * 0.05)(B, Hkv, Sk, Dh)),
            "wq": _w((lambda *s: torch.randn(*s, dtype=torch.bfloat16) * 0.8)(D, Hq * Dh) * (D ** -0.5)),
            "wo": _w((lambda *s: torch.randn(*s, dtype=torch.bfloat16) * 0.05)(Hq * Dh, D) * ((Hq * Dh) ** -0.5)),
        }
    _A_in = _A_setup()

    def _B_setup():
        B, Sq, D = 16, 32, 512
        H, Sk, Dh = 32, 32, 128
        return {
            "x": _w((lambda *s: torch.randn(*s, dtype=torch.bfloat16) * 0.8)(B, Sq, D)),
            "k_cache": _w((lambda *s: torch.randn(*s, dtype=torch.bfloat16) * 0.8)(B, H, Sk, Dh)),
            "v_cache": _w((lambda *s: torch.randn(*s, dtype=torch.bfloat16) * 0.05)(B, H, Sk, Dh)),
            "wq": _w((lambda *s: torch.randn(*s, dtype=torch.bfloat16) * 0.8)(D, H * Dh) * (D ** -0.5)),
            "wo": _w((lambda *s: torch.randn(*s, dtype=torch.bfloat16) * 0.05)(H * Dh, D) * ((H * Dh) ** -0.5)),
        }
    _B_in = _B_setup()

    return {
        "A_x": _A_in["x"],
        "A_k_cache": _A_in["k_cache"],
        "A_v_cache": _A_in["v_cache"],
        "A_wq": _A_in["wq"],
        "A_wo": _A_in["wo"],
        "B_x": _B_in["x"],
        "B_k_cache": _B_in["k_cache"],
        "B_v_cache": _B_in["v_cache"],
        "B_wq": _B_in["wq"],
        "B_wo": _B_in["wo"],
    }

def reference(A_x, A_k_cache, A_v_cache, A_wq, A_wo, B_x, B_k_cache, B_v_cache, B_wq, B_wo):
    def _A_ref(x, k_cache, v_cache, wq, wo):
        B, Sq, D = x.shape
        Hq, Dh = 32, 128
        Hkv = k_cache.shape[1]
        rep = Hq // Hkv
        q = (lambda x, *d: x.permute(*d))((x @ wq).reshape(B, Sq, Hq, Dh), 0, 2, 1, 3)
        k = (lambda x, n, axis: torch.repeat_interleave(x, n, dim=axis))(k_cache, rep, axis=1)
        v = (lambda x, n, axis: torch.repeat_interleave(x, n, dim=axis))(v_cache, rep, axis=1)
        scores = torch.einsum("bhqd,bhkd->bhqk", q, k) * (Dh ** -0.5)
        p = _softmax(scores, axis=-1)
        o = torch.einsum("bhqk,bhkd->bhqd", p, v)
        return (lambda x, *d: x.permute(*d))(o, 0, 2, 1, 3).reshape(B, Sq, Hq * Dh) @ wo

    def _B_ref(x, k_cache, v_cache, wq, wo):
        B, Sq, D = x.shape
        H, Dh = 32, 128
        q = (lambda x, *d: x.permute(*d))((x @ wq).reshape(B, Sq, H, Dh), 0, 2, 1, 3)
        scores = torch.einsum("bhqd,bhkd->bhqk", q, k_cache) * (Dh ** -0.5)
        p = _softmax(scores, axis=-1)
        o = torch.einsum("bhqk,bhkd->bhqd", p, v_cache)
        return (lambda x, *d: x.permute(*d))(o, 0, 2, 1, 3).reshape(B, Sq, H * Dh) @ wo

    a = _A_ref(A_x, A_k_cache, A_v_cache, A_wq, A_wo)
    b = _B_ref(B_x, B_k_cache, B_v_cache, B_wq, B_wo)
    return torch.concatenate([a, b], axis=-1)
```

```asm
; @launch grid=(256,1,1) block=(512,1,1) lds=163840
.amdgcn_target "amdgcn-amd-amdhsa--gfx950"
.text
.globl concat_heads__gqa_block_cached__mha_block_cached__near_ridge_kernel
.p2align 8
.type concat_heads__gqa_block_cached__mha_block_cached__near_ridge_kernel,@function
concat_heads__gqa_block_cached__mha_block_cached__near_ridge_kernel:
s_cmp_ge_u32 s2, 256
s_cbranch_scc1 Lend
s_load_dwordx16 s[4:19], s[0:1], 0
s_load_dwordx8 s[20:27], s[0:1], 64
s_load_dwordx2 s[28:29], s[0:1], 96
v_lshrrev_b32 v2, 6, v0
v_and_b32 v1, 63, v0
v_readfirstlane_b32 s95, v2
s_and_b32 s36, s2, 7
s_lshr_b32 s37, s2, 3
s_lshr_b32 s30, s36, 2
s_and_b32 s36, s36, 3
s_lshl_b32 s36, s36, 3
s_and_b32 s38, s37, 7
s_add_u32 s31, s36, s38
s_lshr_b32 s32, s37, 3
s_lshr_b32 s34, s31, 2
s_and_b32 s35, s31, 3
s_and_b32 s34, s2, 7
s_bfe_u32 s30, s2, 0x10003
s_bfe_u32 s35, s2, 0x20004
s_lshl_b32 s31, s34, 2
s_add_u32 s31, s31, s35
s_and_b32 s3, s95, 3
s_lshl_b32 s76, s3, 12
s_lshl_b32 s77, s3, 13
s_lshl_b32 s39, s30, 2
s_add_u32 s39, s39, s32
s_cmp_lt_u32 s95, 4
s_cbranch_scc1 Lcomp
s_lshl_b32 s33, s32, 2
s_add_u32 s33, s33, s3
s_lshl_b32 s72, s33, 15
s_lshl_b32 s73, s3, 17
s_lshl_b32 s36, s31, 8
s_add_u32 s73, s73, s36
v_lshrrev_b32 v2, 4, v1
v_and_b32 v3, 15, v1
v_lshlrev_b32 v4, 2, v2
v_xor_b32 v4, v4, v3
v_lshlrev_b32 v4, 4, v4
v_lshl_add_u32 v16, v2, 13, v4
v_xor_b32 v5, 32, v16
v_add_u32 v17, 31744, v16
v_add_u32 v18, 63488, v5
v_add_u32 v19, 95232, v5
v_lshrrev_b32 v5, 3, v1
v_and_b32 v6, 7, v1
v_xor_b32 v6, v6, v2
v_lshlrev_b32 v6, 4, v6
v_lshl_add_u32 v20, v5, 10, v6
v_xor_b32 v7, 64, v20
v_add_u32 v21, 7168, v7
v_add_u32 v22, 14336, v20
v_add_u32 v23, 21504, v7
s_mov_b32 s46, 0x400000
s_mov_b32 s47, 0x20000
s_mov_b32 s42, 0x80000
s_mov_b32 s43, 0x20000
s_cmp_eq_u32 s30, 0
s_waitcnt lgkmcnt(0)
s_cselect_b32 s44, s10, s20
s_cselect_b32 s45, s11, s21
s_cselect_b32 s40, s4, s14
s_cselect_b32 s41, s5, s15
s_add_u32 m0, s76, 0
s_add_u32 s78, s73, 0
buffer_load_dwordx4 v16, s[44:47], s78 offen offset:0 lds
buffer_load_dwordx4 v17, s[44:47], s78 offen offset:1024 lds
buffer_load_dwordx4 v18, s[44:47], s78 offen offset:2048 lds
buffer_load_dwordx4 v19, s[44:47], s78 offen offset:3072 lds
s_add_u32 m0, s76, 16384
s_add_u32 s79, s72, 0
buffer_load_dwordx4 v20, s[40:43], s79 offen offset:0 lds
buffer_load_dwordx4 v21, s[40:43], s79 offen offset:1024 lds
buffer_load_dwordx4 v22, s[40:43], s79 offen offset:2048 lds
buffer_load_dwordx4 v23, s[40:43], s79 offen offset:3072 lds
s_cmp_eq_u32 s30, 0
s_cselect_b32 s48, s6, s16
s_cselect_b32 s49, s7, s17
s_cselect_b32 s52, s8, s18
s_cselect_b32 s53, s9, s19
s_cselect_b32 s56, s12, s22
s_cselect_b32 s57, s13, s23
s_mov_b32 s36, 0x100000
s_cselect_b32 s50, s36, 0x400000
s_cselect_b32 s36, 16, 18
s_cselect_b32 s37, s34, s31
s_lshl_b32 s74, s33, s36
s_lshl_b32 s37, s37, 13
s_add_u32 s74, s74, s37
s_mov_b32 s51, 0x20000
s_mov_b32 s54, s50
s_mov_b32 s55, 0x20000
s_mov_b32 s58, 0x400000
s_mov_b32 s59, 0x20000
s_mov_b32 s60, s28
s_mov_b32 s61, s29
s_mov_b32 s62, 0x10000000
s_mov_b32 s63, 0x20000
s_mov_b32 s68, s26
s_mov_b32 s69, s27
s_mov_b32 s70, 256
s_mov_b32 s71, 0x20000
s_lshl_b32 s75, s39, 5
s_add_u32 s36, s75, s31
s_lshl_b32 s36, s36, 2
s_add_u32 s36, s36, s3
s_lshl_b32 s80, s36, 13
s_lshl_b32 s96, s36, 8
s_add_u32 s96, s96, 16777216
s_getreg_b32 s97, hwreg(HW_REG_XCC_ID, 0, 3)
s_lshl_b32 s97, s97, 2
s_lshl_b32 s36, s39, 2
s_add_u32 s36, s36, s35
s_lshl_b32 s36, s36, 18
s_add_u32 s36, s36, 8388608
s_lshl_b32 s37, s34, 15
s_add_u32 s84, s36, s37
s_add_u32 s84, s84, s77
s_lshl_b32 s37, s34, 12
s_add_u32 s85, s36, s37
s_lshl_b32 s37, s3, 10
s_add_u32 s85, s85, s37
v_lshlrev_b32 v8, 2, v1
v_mov_b32 v9, 0
buffer_store_dword v9, v8, s[60:63], s96 offen sc1
s_add_u32 m0, s76, 32768
s_add_u32 s78, s73, 524288
buffer_load_dwordx4 v16, s[44:47], s78 offen offset:0 lds
buffer_load_dwordx4 v17, s[44:47], s78 offen offset:1024 lds
buffer_load_dwordx4 v18, s[44:47], s78 offen offset:2048 lds
buffer_load_dwordx4 v19, s[44:47], s78 offen offset:3072 lds
s_add_u32 m0, s76, 49152
s_add_u32 s79, s72, 128
buffer_load_dwordx4 v20, s[40:43], s79 offen offset:0 lds
buffer_load_dwordx4 v21, s[40:43], s79 offen offset:1024 lds
buffer_load_dwordx4 v22, s[40:43], s79 offen offset:2048 lds
buffer_load_dwordx4 v23, s[40:43], s79 offen offset:3072 lds
s_lshl_b32 s36, s3, 15
s_lshl_b32 s37, s35, 8
s_add_u32 s36, s36, s37
s_lshl_b32 s37, s34, 19
s_add_u32 s36, s36, s37
s_add_u32 s37, s35, 0
s_and_b32 s37, s37, 3
s_lshl_b32 s37, s37, 17
s_add_u32 s90, s36, s37
s_add_u32 s37, s35, 1
s_and_b32 s37, s37, 3
s_lshl_b32 s37, s37, 17
s_add_u32 s91, s36, s37
s_add_u32 s37, s35, 2
s_and_b32 s37, s37, 3
s_lshl_b32 s37, s37, 17
s_add_u32 s92, s36, s37
s_add_u32 s37, s35, 3
s_and_b32 s37, s37, 3
s_lshl_b32 s37, s37, 17
s_add_u32 s93, s36, s37
v_lshl_add_u32 v28, v2, 8, v4
v_lshl_add_u32 v29, v2, 10, v4
v_xor_b32 v5, 32, v29
v_xor_b32 v33, 32, v28
v_add_u32 v30, 3072, v5
v_add_u32 v31, 6144, v29
v_add_u32 v32, 9216, v5
v_xor_b32 v5, v3, v2
v_lshlrev_b32 v5, 4, v5
v_lshl_add_u32 v24, v2, 8, v5
v_xor_b32 v25, 64, v24
v_xor_b32 v26, 128, v24
v_xor_b32 v27, 192, v24
s_lshl_b32 s36, 1, s97
v_mov_b32 v10, s36
s_lshl_b32 s36, s34, 2
s_add_u32 s75, s75, s36
v_lshlrev_b32 v11, 4, v1
v_mov_b32 v12, -1
v_mov_b32 v13, -1
v_mov_b32 v14, -1
v_mov_b32 v15, -1
s_add_u32 s94, s84, 4096
s_waitcnt vmcnt(9)
s_barrier
s_add_u32 m0, s76, 65536
s_add_u32 s78, s73, 1048576
buffer_load_dwordx4 v16, s[44:47], s78 offen offset:0 lds
buffer_load_dwordx4 v17, s[44:47], s78 offen offset:1024 lds
buffer_load_dwordx4 v18, s[44:47], s78 offen offset:2048 lds
buffer_load_dwordx4 v19, s[44:47], s78 offen offset:3072 lds
s_add_u32 m0, s76, 81920
s_add_u32 s79, s72, 256
buffer_load_dwordx4 v20, s[40:43], s79 offen offset:0 lds
buffer_load_dwordx4 v21, s[40:43], s79 offen offset:1024 lds
buffer_load_dwordx4 v22, s[40:43], s79 offen offset:2048 lds
buffer_load_dwordx4 v23, s[40:43], s79 offen offset:3072 lds
s_waitcnt vmcnt(8)
s_barrier
s_cmp_lg_u32 s3, 0
s_cbranch_scc1 Lnoatom
s_mov_b64 exec, 1
buffer_atomic_add v10, v9, s[68:71], s75 offen sc1
s_mov_b64 exec, -1
Lnoatom:
s_add_u32 m0, s76, 98304
s_add_u32 s78, s73, 1572864
buffer_load_dwordx4 v16, s[44:47], s78 offen offset:0 lds
buffer_load_dwordx4 v17, s[44:47], s78 offen offset:1024 lds
buffer_load_dwordx4 v18, s[44:47], s78 offen offset:2048 lds
buffer_load_dwordx4 v19, s[44:47], s78 offen offset:3072 lds
s_add_u32 m0, s76, 114688
s_add_u32 s79, s72, 384
buffer_load_dwordx4 v20, s[40:43], s79 offen offset:0 lds
buffer_load_dwordx4 v21, s[40:43], s79 offen offset:1024 lds
buffer_load_dwordx4 v22, s[40:43], s79 offen offset:2048 lds
buffer_load_dwordx4 v23, s[40:43], s79 offen offset:3072 lds
s_waitcnt vmcnt(8)
s_barrier
s_add_u32 m0, s76, 131072
s_add_u32 s78, s73, 2097152
buffer_load_dwordx4 v16, s[44:47], s78 offen offset:0 lds
buffer_load_dwordx4 v17, s[44:47], s78 offen offset:1024 lds
buffer_load_dwordx4 v18, s[44:47], s78 offen offset:2048 lds
buffer_load_dwordx4 v19, s[44:47], s78 offen offset:3072 lds
s_add_u32 m0, s76, 147456
s_add_u32 s79, s72, 512
buffer_load_dwordx4 v20, s[40:43], s79 offen offset:0 lds
buffer_load_dwordx4 v21, s[40:43], s79 offen offset:1024 lds
buffer_load_dwordx4 v22, s[40:43], s79 offen offset:2048 lds
buffer_load_dwordx4 v23, s[40:43], s79 offen offset:3072 lds
s_waitcnt vmcnt(8)
s_barrier
s_add_u32 m0, s76, 0
s_add_u32 s78, s73, 2621440
buffer_load_dwordx4 v16, s[44:47], s78 offen offset:0 lds
buffer_load_dwordx4 v17, s[44:47], s78 offen offset:1024 lds
buffer_load_dwordx4 v18, s[44:47], s78 offen offset:2048 lds
buffer_load_dwordx4 v19, s[44:47], s78 offen offset:3072 lds
s_add_u32 m0, s76, 16384
s_add_u32 s79, s72, 640
buffer_load_dwordx4 v20, s[40:43], s79 offen offset:0 lds
buffer_load_dwordx4 v21, s[40:43], s79 offen offset:1024 lds
buffer_load_dwordx4 v22, s[40:43], s79 offen offset:2048 lds
buffer_load_dwordx4 v23, s[40:43], s79 offen offset:3072 lds
s_waitcnt vmcnt(8)
s_barrier
s_add_u32 m0, s76, 32768
s_add_u32 s78, s73, 3145728
buffer_load_dwordx4 v16, s[44:47], s78 offen offset:0 lds
buffer_load_dwordx4 v17, s[44:47], s78 offen offset:1024 lds
buffer_load_dwordx4 v18, s[44:47], s78 offen offset:2048 lds
buffer_load_dwordx4 v19, s[44:47], s78 offen offset:3072 lds
s_add_u32 m0, s76, 49152
s_add_u32 s79, s72, 768
buffer_load_dwordx4 v20, s[40:43], s79 offen offset:0 lds
buffer_load_dwordx4 v21, s[40:43], s79 offen offset:1024 lds
buffer_load_dwordx4 v22, s[40:43], s79 offen offset:2048 lds
buffer_load_dwordx4 v23, s[40:43], s79 offen offset:3072 lds
s_waitcnt vmcnt(8)
s_barrier
s_add_u32 m0, s76, 65536
s_add_u32 s78, s73, 3670016
buffer_load_dwordx4 v16, s[44:47], s78 offen offset:0 lds
buffer_load_dwordx4 v17, s[44:47], s78 offen offset:1024 lds
buffer_load_dwordx4 v18, s[44:47], s78 offen offset:2048 lds
buffer_load_dwordx4 v19, s[44:47], s78 offen offset:3072 lds
s_add_u32 m0, s76, 81920
s_add_u32 s79, s72, 896
buffer_load_dwordx4 v20, s[40:43], s79 offen offset:0 lds
buffer_load_dwordx4 v21, s[40:43], s79 offen offset:1024 lds
buffer_load_dwordx4 v22, s[40:43], s79 offen offset:2048 lds
buffer_load_dwordx4 v23, s[40:43], s79 offen offset:3072 lds
s_waitcnt vmcnt(8)
s_barrier
s_add_u32 m0, s77, 98304
s_add_u32 s78, s74, 0
buffer_load_dwordx4 v24, s[48:51], s78 offen offset:0 lds
buffer_load_dwordx4 v25, s[48:51], s78 offen offset:1024 lds
buffer_load_dwordx4 v26, s[48:51], s78 offen offset:2048 lds
buffer_load_dwordx4 v27, s[48:51], s78 offen offset:3072 lds
s_add_u32 m0, s77, 102400
s_add_u32 s78, s74, 4096
buffer_load_dwordx4 v24, s[48:51], s78 offen offset:0 lds
buffer_load_dwordx4 v25, s[48:51], s78 offen offset:1024 lds
buffer_load_dwordx4 v26, s[48:51], s78 offen offset:2048 lds
buffer_load_dwordx4 v27, s[48:51], s78 offen offset:3072 lds
s_waitcnt vmcnt(8)
s_barrier
s_add_u32 m0, s77, 131072
s_add_u32 s78, s74, 0
buffer_load_dwordx4 v28, s[52:55], s78 offen offset:0 lds
buffer_load_dwordx4 v33, s[52:55], s78 offen offset:1024 lds
buffer_load_dwordx4 v28, s[52:55], s78 offen offset:2048 lds
buffer_load_dwordx4 v33, s[52:55], s78 offen offset:3072 lds
s_add_u32 m0, s77, 135168
s_add_u32 s78, s74, 4096
buffer_load_dwordx4 v28, s[52:55], s78 offen offset:0 lds
buffer_load_dwordx4 v33, s[52:55], s78 offen offset:1024 lds
buffer_load_dwordx4 v28, s[52:55], s78 offen offset:2048 lds
buffer_load_dwordx4 v33, s[52:55], s78 offen offset:3072 lds
s_waitcnt vmcnt(8)
s_barrier
s_add_u32 m0, s77, 0
s_add_u32 s78, s90, 0
buffer_load_dwordx4 v29, s[56:59], s78 offen offset:0 lds
buffer_load_dwordx4 v30, s[56:59], s78 offen offset:1024 lds
buffer_load_dwordx4 v31, s[56:59], s78 offen offset:2048 lds
buffer_load_dwordx4 v32, s[56:59], s78 offen offset:3072 lds
s_add_u32 m0, s77, 4096
s_add_u32 s78, s90, 16384
buffer_load_dwordx4 v29, s[56:59], s78 offen offset:0 lds
buffer_load_dwordx4 v30, s[56:59], s78 offen offset:1024 lds
buffer_load_dwordx4 v31, s[56:59], s78 offen offset:2048 lds
buffer_load_dwordx4 v32, s[56:59], s78 offen offset:3072 lds
s_waitcnt vmcnt(8)
s_barrier
s_add_u32 m0, s77, 32768
s_add_u32 s78, s91, 0
buffer_load_dwordx4 v29, s[56:59], s78 offen offset:0 lds
buffer_load_dwordx4 v30, s[56:59], s78 offen offset:1024 lds
buffer_load_dwordx4 v31, s[56:59], s78 offen offset:2048 lds
buffer_load_dwordx4 v32, s[56:59], s78 offen offset:3072 lds
s_add_u32 m0, s77, 36864
s_add_u32 s78, s91, 16384
buffer_load_dwordx4 v29, s[56:59], s78 offen offset:0 lds
buffer_load_dwordx4 v30, s[56:59], s78 offen offset:1024 lds
buffer_load_dwordx4 v31, s[56:59], s78 offen offset:2048 lds
buffer_load_dwordx4 v32, s[56:59], s78 offen offset:3072 lds
s_waitcnt vmcnt(8)
s_barrier
s_add_u32 m0, s77, 65536
s_add_u32 s78, s92, 0
buffer_load_dwordx4 v29, s[56:59], s78 offen offset:0 lds
buffer_load_dwordx4 v30, s[56:59], s78 offen offset:1024 lds
buffer_load_dwordx4 v31, s[56:59], s78 offen offset:2048 lds
buffer_load_dwordx4 v32, s[56:59], s78 offen offset:3072 lds
s_add_u32 m0, s77, 69632
s_add_u32 s78, s92, 16384
buffer_load_dwordx4 v29, s[56:59], s78 offen offset:0 lds
buffer_load_dwordx4 v30, s[56:59], s78 offen offset:1024 lds
buffer_load_dwordx4 v31, s[56:59], s78 offen offset:2048 lds
buffer_load_dwordx4 v32, s[56:59], s78 offen offset:3072 lds
s_waitcnt vmcnt(8)
s_barrier
s_add_u32 m0, s77, 98304
s_add_u32 s78, s93, 0
buffer_load_dwordx4 v29, s[56:59], s78 offen offset:0 lds
buffer_load_dwordx4 v30, s[56:59], s78 offen offset:1024 lds
buffer_load_dwordx4 v31, s[56:59], s78 offen offset:2048 lds
buffer_load_dwordx4 v32, s[56:59], s78 offen offset:3072 lds
s_add_u32 m0, s77, 102400
s_add_u32 s78, s93, 16384
buffer_load_dwordx4 v29, s[56:59], s78 offen offset:0 lds
buffer_load_dwordx4 v30, s[56:59], s78 offen offset:1024 lds
buffer_load_dwordx4 v31, s[56:59], s78 offen offset:2048 lds
buffer_load_dwordx4 v32, s[56:59], s78 offen offset:3072 lds
s_waitcnt vmcnt(0)
s_barrier
s_endpgm
Lcomp:
v_and_b32 v28, 15, v1
v_and_b32 v29, 31, v1
v_lshrrev_b32 v30, 4, v1
v_bfe_u32 v31, v1, 2, 2
v_and_b32 v2, 3, v1
v_lshlrev_b32 v2, 3, v2
v_bfe_u32 v3, v1, 4, 1
v_lshl_or_b32 v2, v3, 5, v2
v_lshl_or_b32 v2, v31, 6, v2
v_lshl_or_b32 v2, v31, 8, v2
v_lshl_or_b32 v156, v30, 11, v2
v_lshl_or_b32 v16, v30, 10, v2
v_xor_b32 v157, 32, v156
v_xor_b32 v158, 64, v156
v_xor_b32 v159, 96, v156
v_xor_b32 v160, 128, v156
v_xor_b32 v161, 160, v156
v_xor_b32 v162, 192, v156
v_xor_b32 v163, 224, v156
v_bfe_u32 v3, v1, 1, 3
v_xor_b32 v3, v3, v30
v_lshlrev_b32 v3, 4, v3
v_lshl_or_b32 v3, v28, 7, v3
s_add_u32 s36, s76, 16384
v_add_u32 v180, s36, v3
v_xor_b32 v181, 64, v180
v_add_u32 v164, 65536, v156
v_add_u32 v165, 65536, v157
v_add_u32 v166, 65536, v158
v_add_u32 v167, 65536, v159
v_add_u32 v168, 65536, v160
v_add_u32 v169, 65536, v161
v_add_u32 v170, 65536, v162
v_add_u32 v171, 65536, v163
v_add_u32 v182, 65536, v180
v_add_u32 v183, 65536, v181
v_add_u32 v172, 131072, v156
v_add_u32 v173, 131072, v157
v_add_u32 v174, 131072, v158
v_add_u32 v175, 131072, v159
v_add_u32 v176, 131072, v160
v_add_u32 v177, 131072, v161
v_add_u32 v178, 131072, v162
v_add_u32 v179, 131072, v163
v_add_u32 v184, 131072, v180
v_add_u32 v185, 131072, v181
s_add_u32 s36, s77, 131072
v_add_u32 v24, 0x10000, v16
v_add_u32 v228, s36, v16
v_xor_b32 v17, 32, v16
v_add_u32 v25, 0x10000, v17
v_add_u32 v229, s36, v17
v_xor_b32 v18, 64, v16
v_add_u32 v26, 0x10000, v18
v_add_u32 v230, s36, v18
v_xor_b32 v19, 96, v16
v_add_u32 v27, 0x10000, v19
v_add_u32 v231, s36, v19
v_xor_b32 v20, 128, v16
v_add_u32 v252, 0x10000, v20
v_add_u32 v232, s36, v20
v_xor_b32 v21, 160, v16
v_add_u32 v253, 0x10000, v21
v_add_u32 v233, s36, v21
v_xor_b32 v22, 192, v16
v_add_u32 v254, 0x10000, v22
v_add_u32 v234, s36, v22
v_xor_b32 v23, 224, v16
v_add_u32 v255, 0x10000, v23
v_add_u32 v235, s36, v23
v_lshrrev_b32 v3, 5, v1
v_xor_b32 v3, v28, v3
v_lshlrev_b32 v3, 4, v3
v_lshl_or_b32 v3, v28, 8, v3
v_bfe_u32 v4, v1, 4, 1
v_lshl_or_b32 v3, v4, 3, v3
s_add_u32 s36, s77, 98304
v_add_u32 v220, s36, v3
v_xor_b32 v221, 32, v220
v_xor_b32 v222, 64, v220
v_xor_b32 v223, 96, v220
v_xor_b32 v224, 128, v220
v_xor_b32 v225, 160, v220
v_xor_b32 v226, 192, v220
v_xor_b32 v227, 224, v220
v_lshlrev_b32 v6, 4, v1
v_mov_b32 v11, 1
v_and_b32 v3, 7, v1
v_lshlrev_b32 v14, 2, v3
s_waitcnt lgkmcnt(0)
s_mov_b32 s60, s28
s_mov_b32 s61, s29
s_mov_b32 s62, 0x10000000
s_mov_b32 s63, 0x20000
s_mov_b32 s68, s26
s_mov_b32 s69, s27
s_mov_b32 s70, 256
s_mov_b32 s71, 0x20000
s_lshl_b32 s75, s39, 5
s_add_u32 s36, s75, s31
s_lshl_b32 s36, s36, 2
s_add_u32 s36, s36, s3
s_lshl_b32 s80, s36, 13
s_lshl_b32 s96, s36, 8
s_add_u32 s96, s96, 16777216
s_getreg_b32 s97, hwreg(HW_REG_XCC_ID, 0, 3)
s_lshl_b32 s97, s97, 2
s_lshl_b32 s36, s39, 2
s_add_u32 s36, s36, s35
s_lshl_b32 s36, s36, 18
s_add_u32 s36, s36, 8388608
s_lshl_b32 s37, s34, 15
s_add_u32 s84, s36, s37
s_add_u32 s84, s84, s77
s_lshl_b32 s37, s34, 12
s_add_u32 s85, s36, s37
s_lshl_b32 s37, s3, 10
s_add_u32 s85, s85, s37
s_mov_b32 s64, s24
s_mov_b32 s65, s25
s_mov_b32 s66, 0x100000
s_mov_b32 s67, 0x20000
s_mov_b32 s86, 0x3e0293ee
v_lshlrev_b32 v3, 2, v29
v_add_u32 v7, s96, v3
s_lshl_b32 s38, s35, 15
s_sub_u32 s38, s80, s38
s_add_u32 s37, s35, 1
s_and_b32 s37, s37, 3
s_lshl_b32 s37, s37, 15
s_add_u32 s81, s38, s37
s_add_u32 s91, s81, 4096
s_add_u32 s37, s35, 2
s_and_b32 s37, s37, 3
s_lshl_b32 s37, s37, 15
s_add_u32 s82, s38, s37
s_add_u32 s92, s82, 4096
s_add_u32 s37, s35, 3
s_and_b32 s37, s37, 3
s_lshl_b32 s37, s37, 15
s_add_u32 s83, s38, s37
s_add_u32 s93, s83, 4096
s_lshl_b32 s37, s35, 10
s_sub_u32 s36, s96, s37
s_lshl_b32 s37, s35, 2
s_add_u32 s36, s36, s37
v_and_b32 v3, 3, v1
v_lshlrev_b32 v4, 10, v3
v_add_u32 v8, s36, v4
s_lshl_b32 s37, s3, 3
s_add_u32 s36, s75, s37
s_add_u32 s36, s36, s35
s_lshl_b32 s36, s36, 10
s_lshl_b32 s37, s34, 2
s_add_u32 s36, s36, s37
s_add_u32 s36, s36, 16777344
v_bfe_u32 v4, v1, 2, 1
v_lshlrev_b32 v4, 12, v4
v_lshl_or_b32 v4, v3, 8, v4
v_add_u32 v9, s36, v4
s_lshr_b32 s36, s34, 1
s_lshl_b32 s37, s32, 2
s_add_u32 s36, s36, s37
s_lshl_b32 s36, s36, 16
s_lshl_b32 s37, s30, 10
s_add_u32 s36, s36, s37
s_lshl_b32 s37, s35, 8
s_add_u32 s36, s36, s37
s_and_b32 s37, s34, 1
s_lshl_b32 s37, s37, 7
s_add_u32 s36, s36, s37
s_lshr_b32 s37, s3, 1
s_lshl_b32 s37, s37, 6
s_add_u32 s36, s36, s37
s_and_b32 s37, s3, 1
s_lshl_b32 s37, s37, 15
s_add_u32 s36, s36, s37
v_lshlrev_b32 v3, 11, v28
v_lshl_or_b32 v3, v30, 3, v3
v_add_u32 v10, s36, v3
s_lshl_b32 s97, 4, s97
s_mov_b32 s98, 0x11111111
s_add_u32 s94, s80, 4096
s_barrier
ds_read_b128 v[188:191], v180 offset:0
ds_read_b128 v[192:195], v180 offset:2048
ds_read_b64_tr_b16 v[28:29], v156 offset:0
ds_read_b64_tr_b16 v[30:31], v156 offset:1024
ds_read_b64_tr_b16 v[32:33], v157 offset:0
ds_read_b64_tr_b16 v[34:35], v157 offset:1024
ds_read_b64_tr_b16 v[36:37], v158 offset:0
ds_read_b64_tr_b16 v[38:39], v158 offset:1024
ds_read_b64_tr_b16 v[40:41], v159 offset:0
ds_read_b64_tr_b16 v[42:43], v159 offset:1024
s_waitcnt lgkmcnt(6)
v_mfma_f32_16x16x32_bf16 v[60:63], v[28:31], v[188:191], 0
ds_read_b64_tr_b16 v[44:45], v160 offset:0
v_mfma_f32_16x16x32_bf16 v[64:67], v[28:31], v[192:195], 0
ds_read_b64_tr_b16 v[46:47], v160 offset:1024
s_waitcnt lgkmcnt(6)
v_mfma_f32_16x16x32_bf16 v[68:71], v[32:35], v[188:191], 0
ds_read_b64_tr_b16 v[48:49], v161 offset:0
v_mfma_f32_16x16x32_bf16 v[72:75], v[32:35], v[192:195], 0
ds_read_b64_tr_b16 v[50:51], v161 offset:1024
s_waitcnt lgkmcnt(6)
v_mfma_f32_16x16x32_bf16 v[76:79], v[36:39], v[188:191], 0
ds_read_b64_tr_b16 v[52:53], v162 offset:0
v_mfma_f32_16x16x32_bf16 v[80:83], v[36:39], v[192:195], 0
ds_read_b64_tr_b16 v[54:55], v162 offset:1024
ds_read_b128 v[196:199], v181 offset:0
s_waitcnt lgkmcnt(7)
v_mfma_f32_16x16x32_bf16 v[84:87], v[40:43], v[188:191], 0
ds_read_b64_tr_b16 v[56:57], v163 offset:0
v_mfma_f32_16x16x32_bf16 v[88:91], v[40:43], v[192:195], 0
ds_read_b64_tr_b16 v[58:59], v163 offset:1024
ds_read_b128 v[200:203], v181 offset:2048
s_waitcnt lgkmcnt(8)
v_mfma_f32_16x16x32_bf16 v[92:95], v[44:47], v[188:191], 0
ds_read_b64_tr_b16 v[28:29], v156 offset:8192
v_mfma_f32_16x16x32_bf16 v[96:99], v[44:47], v[192:195], 0
ds_read_b64_tr_b16 v[30:31], v156 offset:9216
s_waitcnt lgkmcnt(8)
v_mfma_f32_16x16x32_bf16 v[100:103], v[48:51], v[188:191], 0
ds_read_b64_tr_b16 v[32:33], v157 offset:8192
v_mfma_f32_16x16x32_bf16 v[104:107], v[48:51], v[192:195], 0
ds_read_b64_tr_b16 v[34:35], v157 offset:9216
s_waitcnt lgkmcnt(8)
v_mfma_f32_16x16x32_bf16 v[108:111], v[52:55], v[188:191], 0
ds_read_b64_tr_b16 v[36:37], v158 offset:8192
v_mfma_f32_16x16x32_bf16 v[112:115], v[52:55], v[192:195], 0
ds_read_b64_tr_b16 v[38:39], v158 offset:9216
s_waitcnt lgkmcnt(7)
v_mfma_f32_16x16x32_bf16 v[116:119], v[56:59], v[188:191], 0
ds_read_b64_tr_b16 v[40:41], v159 offset:8192
v_mfma_f32_16x16x32_bf16 v[120:123], v[56:59], v[192:195], 0
ds_read_b64_tr_b16 v[42:43], v159 offset:9216
s_waitcnt lgkmcnt(6)
v_mfma_f32_16x16x32_bf16 v[60:63], v[28:31], v[196:199], v[60:63]
ds_read_b64_tr_b16 v[44:45], v160 offset:8192
v_mfma_f32_16x16x32_bf16 v[64:67], v[28:31], v[200:203], v[64:67]
ds_read_b64_tr_b16 v[46:47], v160 offset:9216
s_waitcnt lgkmcnt(6)
v_mfma_f32_16x16x32_bf16 v[68:71], v[32:35], v[196:199], v[68:71]
ds_read_b64_tr_b16 v[48:49], v161 offset:8192
v_mfma_f32_16x16x32_bf16 v[72:75], v[32:35], v[200:203], v[72:75]
ds_read_b64_tr_b16 v[50:51], v161 offset:9216
s_waitcnt lgkmcnt(6)
v_mfma_f32_16x16x32_bf16 v[76:79], v[36:39], v[196:199], v[76:79]
ds_read_b64_tr_b16 v[52:53], v162 offset:8192
v_mfma_f32_16x16x32_bf16 v[80:83], v[36:39], v[200:203], v[80:83]
ds_read_b64_tr_b16 v[54:55], v162 offset:9216
s_waitcnt lgkmcnt(6)
v_mfma_f32_16x16x32_bf16 v[84:87], v[40:43], v[196:199], v[84:87]
ds_read_b64_tr_b16 v[56:57], v163 offset:8192
v_mfma_f32_16x16x32_bf16 v[88:91], v[40:43], v[200:203], v[88:91]
ds_read_b64_tr_b16 v[58:59], v163 offset:9216
s_waitcnt lgkmcnt(6)
v_mfma_f32_16x16x32_bf16 v[92:95], v[44:47], v[196:199], v[92:95]
v_mfma_f32_16x16x32_bf16 v[96:99], v[44:47], v[200:203], v[96:99]
s_waitcnt lgkmcnt(4)
v_mfma_f32_16x16x32_bf16 v[100:103], v[48:51], v[196:199], v[100:103]
v_mfma_f32_16x16x32_bf16 v[104:107], v[48:51], v[200:203], v[104:107]
s_waitcnt lgkmcnt(0)
s_barrier
ds_read_b128 v[188:191], v180 offset:32768
ds_read_b128 v[192:195], v180 offset:34816
ds_read_b64_tr_b16 v[28:29], v156 offset:32768
ds_read_b64_tr_b16 v[30:31], v156 offset:33792
ds_read_b64_tr_b16 v[32:33], v157 offset:32768
ds_read_b64_tr_b16 v[34:35], v157 offset:33792
v_mfma_f32_16x16x32_bf16 v[108:111], v[52:55], v[196:199], v[108:111]
ds_read_b64_tr_b16 v[36:37], v158 offset:32768
v_mfma_f32_16x16x32_bf16 v[112:115], v[52:55], v[200:203], v[112:115]
ds_read_b64_tr_b16 v[38:39], v158 offset:33792
v_mfma_f32_16x16x32_bf16 v[116:119], v[56:59], v[196:199], v[116:119]
ds_read_b64_tr_b16 v[40:41], v159 offset:32768
v_mfma_f32_16x16x32_bf16 v[120:123], v[56:59], v[200:203], v[120:123]
ds_read_b64_tr_b16 v[42:43], v159 offset:33792
s_waitcnt lgkmcnt(6)
v_mfma_f32_16x16x32_bf16 v[60:63], v[28:31], v[188:191], v[60:63]
ds_read_b64_tr_b16 v[44:45], v160 offset:32768
v_mfma_f32_16x16x32_bf16 v[64:67], v[28:31], v[192:195], v[64:67]
ds_read_b64_tr_b16 v[46:47], v160 offset:33792
s_waitcnt lgkmcnt(6)
v_mfma_f32_16x16x32_bf16 v[68:71], v[32:35], v[188:191], v[68:71]
ds_read_b64_tr_b16 v[48:49], v161 offset:32768
v_mfma_f32_16x16x32_bf16 v[72:75], v[32:35], v[192:195], v[72:75]
ds_read_b64_tr_b16 v[50:51], v161 offset:33792
s_waitcnt lgkmcnt(6)
v_mfma_f32_16x16x32_bf16 v[76:79], v[36:39], v[188:191], v[76:79]
ds_read_b64_tr_b16 v[52:53], v162 offset:32768
v_mfma_f32_16x16x32_bf16 v[80:83], v[36:39], v[192:195], v[80:83]
ds_read_b64_tr_b16 v[54:55], v162 offset:33792
ds_read_b128 v[196:199], v181 offset:32768
s_waitcnt lgkmcnt(7)
v_mfma_f32_16x16x32_bf16 v[84:87], v[40:43], v[188:191], v[84:87]
ds_read_b64_tr_b16 v[56:57], v163 offset:32768
v_mfma_f32_16x16x32_bf16 v[88:91], v[40:43], v[192:195], v[88:91]
ds_read_b64_tr_b16 v[58:59], v163 offset:33792
ds_read_b128 v[200:203], v181 offset:34816
s_waitcnt lgkmcnt(8)
v_mfma_f32_16x16x32_bf16 v[92:95], v[44:47], v[188:191], v[92:95]
ds_read_b64_tr_b16 v[28:29], v156 offset:40960
v_mfma_f32_16x16x32_bf16 v[96:99], v[44:47], v[192:195], v[96:99]
ds_read_b64_tr_b16 v[30:31], v156 offset:41984
s_waitcnt lgkmcnt(8)
v_mfma_f32_16x16x32_bf16 v[100:103], v[48:51], v[188:191], v[100:103]
ds_read_b64_tr_b16 v[32:33], v157 offset:40960
v_mfma_f32_16x16x32_bf16 v[104:107], v[48:51], v[192:195], v[104:107]
ds_read_b64_tr_b16 v[34:35], v157 offset:41984
s_waitcnt lgkmcnt(8)
v_mfma_f32_16x16x32_bf16 v[108:111], v[52:55], v[188:191], v[108:111]
ds_read_b64_tr_b16 v[36:37], v158 offset:40960
v_mfma_f32_16x16x32_bf16 v[112:115], v[52:55], v[192:195], v[112:115]
ds_read_b64_tr_b16 v[38:39], v158 offset:41984
s_waitcnt lgkmcnt(7)
v_mfma_f32_16x16x32_bf16 v[116:119], v[56:59], v[188:191], v[116:119]
ds_read_b64_tr_b16 v[40:41], v159 offset:40960
v_mfma_f32_16x16x32_bf16 v[120:123], v[56:59], v[192:195], v[120:123]
ds_read_b64_tr_b16 v[42:43], v159 offset:41984
s_waitcnt lgkmcnt(6)
v_mfma_f32_16x16x32_bf16 v[60:63], v[28:31], v[196:199], v[60:63]
ds_read_b64_tr_b16 v[44:45], v160 offset:40960
v_mfma_f32_16x16x32_bf16 v[64:67], v[28:31], v[200:203], v[64:67]
ds_read_b64_tr_b16 v[46:47], v160 offset:41984
s_waitcnt lgkmcnt(6)
v_mfma_f32_16x16x32_bf16 v[68:71], v[32:35], v[196:199], v[68:71]
ds_read_b64_tr_b16 v[48:49], v161 offset:40960
v_mfma_f32_16x16x32_bf16 v[72:75], v[32:35], v[200:203], v[72:75]
ds_read_b64_tr_b16 v[50:51], v161 offset:41984
s_waitcnt lgkmcnt(6)
v_mfma_f32_16x16x32_bf16 v[76:79], v[36:39], v[196:199], v[76:79]
ds_read_b64_tr_b16 v[52:53], v162 offset:40960
v_mfma_f32_16x16x32_bf16 v[80:83], v[36:39], v[200:203], v[80:83]
ds_read_b64_tr_b16 v[54:55], v162 offset:41984
s_waitcnt lgkmcnt(6)
v_mfma_f32_16x16x32_bf16 v[84:87], v[40:43], v[196:199], v[84:87]
ds_read_b64_tr_b16 v[56:57], v163 offset:40960
v_mfma_f32_16x16x32_bf16 v[88:91], v[40:43], v[200:203], v[88:91]
ds_read_b64_tr_b16 v[58:59], v163 offset:41984
s_waitcnt lgkmcnt(6)
v_mfma_f32_16x16x32_bf16 v[92:95], v[44:47], v[196:199], v[92:95]
v_mfma_f32_16x16x32_bf16 v[96:99], v[44:47], v[200:203], v[96:99]
s_waitcnt lgkmcnt(4)
v_mfma_f32_16x16x32_bf16 v[100:103], v[48:51], v[196:199], v[100:103]
v_mfma_f32_16x16x32_bf16 v[104:107], v[48:51], v[200:203], v[104:107]
s_waitcnt lgkmcnt(0)
s_barrier
ds_read_b128 v[188:191], v182 offset:0
ds_read_b128 v[192:195], v182 offset:2048
ds_read_b64_tr_b16 v[28:29], v164 offset:0
ds_read_b64_tr_b16 v[30:31], v164 offset:1024
ds_read_b64_tr_b16 v[32:33], v165 offset:0
ds_read_b64_tr_b16 v[34:35], v165 offset:1024
v_mfma_f32_16x16x32_bf16 v[108:111], v[52:55], v[196:199], v[108:111]
ds_read_b64_tr_b16 v[36:37], v166 offset:0
v_mfma_f32_16x16x32_bf16 v[112:115], v[52:55], v[200:203], v[112:115]
ds_read_b64_tr_b16 v[38:39], v166 offset:1024
v_mfma_f32_16x16x32_bf16 v[116:119], v[56:59], v[196:199], v[116:119]
ds_read_b64_tr_b16 v[40:41], v167 offset:0
v_mfma_f32_16x16x32_bf16 v[120:123], v[56:59], v[200:203], v[120:123]
ds_read_b64_tr_b16 v[42:43], v167 offset:1024
s_waitcnt lgkmcnt(6)
v_mfma_f32_16x16x32_bf16 v[60:63], v[28:31], v[188:191], v[60:63]
ds_read_b64_tr_b16 v[44:45], v168 offset:0
v_mfma_f32_16x16x32_bf16 v[64:67], v[28:31], v[192:195], v[64:67]
ds_read_b64_tr_b16 v[46:47], v168 offset:1024
s_waitcnt lgkmcnt(6)
v_mfma_f32_16x16x32_bf16 v[68:71], v[32:35], v[188:191], v[68:71]
ds_read_b64_tr_b16 v[48:49], v169 offset:0
v_mfma_f32_16x16x32_bf16 v[72:75], v[32:35], v[192:195], v[72:75]
ds_read_b64_tr_b16 v[50:51], v169 offset:1024
s_waitcnt lgkmcnt(6)
v_mfma_f32_16x16x32_bf16 v[76:79], v[36:39], v[188:191], v[76:79]
ds_read_b64_tr_b16 v[52:53], v170 offset:0
v_mfma_f32_16x16x32_bf16 v[80:83], v[36:39], v[192:195], v[80:83]
ds_read_b64_tr_b16 v[54:55], v170 offset:1024
ds_read_b128 v[196:199], v183 offset:0
s_waitcnt lgkmcnt(7)
v_mfma_f32_16x16x32_bf16 v[84:87], v[40:43], v[188:191], v[84:87]
ds_read_b64_tr_b16 v[56:57], v171 offset:0
v_mfma_f32_16x16x32_bf16 v[88:91], v[40:43], v[192:195], v[88:91]
ds_read_b64_tr_b16 v[58:59], v171 offset:1024
ds_read_b128 v[200:203], v183 offset:2048
s_waitcnt lgkmcnt(8)
v_mfma_f32_16x16x32_bf16 v[92:95], v[44:47], v[188:191], v[92:95]
ds_read_b64_tr_b16 v[28:29], v164 offset:8192
v_mfma_f32_16x16x32_bf16 v[96:99], v[44:47], v[192:195], v[96:99]
ds_read_b64_tr_b16 v[30:31], v164 offset:9216
s_waitcnt lgkmcnt(8)
v_mfma_f32_16x16x32_bf16 v[100:103], v[48:51], v[188:191], v[100:103]
ds_read_b64_tr_b16 v[32:33], v165 offset:8192
v_mfma_f32_16x16x32_bf16 v[104:107], v[48:51], v[192:195], v[104:107]
ds_read_b64_tr_b16 v[34:35], v165 offset:9216
s_waitcnt lgkmcnt(8)
v_mfma_f32_16x16x32_bf16 v[108:111], v[52:55], v[188:191], v[108:111]
ds_read_b64_tr_b16 v[36:37], v166 offset:8192
v_mfma_f32_16x16x32_bf16 v[112:115], v[52:55], v[192:195], v[112:115]
ds_read_b64_tr_b16 v[38:39], v166 offset:9216
s_waitcnt lgkmcnt(7)
v_mfma_f32_16x16x32_bf16 v[116:119], v[56:59], v[188:191], v[116:119]
ds_read_b64_tr_b16 v[40:41], v167 offset:8192
v_mfma_f32_16x16x32_bf16 v[120:123], v[56:59], v[192:195], v[120:123]
ds_read_b64_tr_b16 v[42:43], v167 offset:9216
s_waitcnt lgkmcnt(6)
v_mfma_f32_16x16x32_bf16 v[60:63], v[28:31], v[196:199], v[60:63]
ds_read_b64_tr_b16 v[44:45], v168 offset:8192
v_mfma_f32_16x16x32_bf16 v[64:67], v[28:31], v[200:203], v[64:67]
ds_read_b64_tr_b16 v[46:47], v168 offset:9216
s_waitcnt lgkmcnt(6)
v_mfma_f32_16x16x32_bf16 v[68:71], v[32:35], v[196:199], v[68:71]
ds_read_b64_tr_b16 v[48:49], v169 offset:8192
v_mfma_f32_16x16x32_bf16 v[72:75], v[32:35], v[200:203], v[72:75]
ds_read_b64_tr_b16 v[50:51], v169 offset:9216
s_waitcnt lgkmcnt(6)
v_mfma_f32_16x16x32_bf16 v[76:79], v[36:39], v[196:199], v[76:79]
ds_read_b64_tr_b16 v[52:53], v170 offset:8192
v_mfma_f32_16x16x32_bf16 v[80:83], v[36:39], v[200:203], v[80:83]
ds_read_b64_tr_b16 v[54:55], v170 offset:9216
s_waitcnt lgkmcnt(6)
v_mfma_f32_16x16x32_bf16 v[84:87], v[40:43], v[196:199], v[84:87]
ds_read_b64_tr_b16 v[56:57], v171 offset:8192
v_mfma_f32_16x16x32_bf16 v[88:91], v[40:43], v[200:203], v[88:91]
ds_read_b64_tr_b16 v[58:59], v171 offset:9216
s_waitcnt lgkmcnt(6)
v_mfma_f32_16x16x32_bf16 v[92:95], v[44:47], v[196:199], v[92:95]
v_mfma_f32_16x16x32_bf16 v[96:99], v[44:47], v[200:203], v[96:99]
s_waitcnt lgkmcnt(4)
v_mfma_f32_16x16x32_bf16 v[100:103], v[48:51], v[196:199], v[100:103]
v_mfma_f32_16x16x32_bf16 v[104:107], v[48:51], v[200:203], v[104:107]
s_waitcnt lgkmcnt(0)
s_barrier
ds_read_b128 v[188:191], v182 offset:32768
ds_read_b128 v[192:195], v182 offset:34816
ds_read_b64_tr_b16 v[28:29], v164 offset:32768
ds_read_b64_tr_b16 v[30:31], v164 offset:33792
ds_read_b64_tr_b16 v[32:33], v165 offset:32768
ds_read_b64_tr_b16 v[34:35], v165 offset:33792
v_mfma_f32_16x16x32_bf16 v[108:111], v[52:55], v[196:199], v[108:111]
ds_read_b64_tr_b16 v[36:37], v166 offset:32768
v_mfma_f32_16x16x32_bf16 v[112:115], v[52:55], v[200:203], v[112:115]
ds_read_b64_tr_b16 v[38:39], v166 offset:33792
v_mfma_f32_16x16x32_bf16 v[116:119], v[56:59], v[196:199], v[116:119]
ds_read_b64_tr_b16 v[40:41], v167 offset:32768
v_mfma_f32_16x16x32_bf16 v[120:123], v[56:59], v[200:203], v[120:123]
ds_read_b64_tr_b16 v[42:43], v167 offset:33792
s_waitcnt lgkmcnt(6)
v_mfma_f32_16x16x32_bf16 v[60:63], v[28:31], v[188:191], v[60:63]
ds_read_b64_tr_b16 v[44:45], v168 offset:32768
v_mfma_f32_16x16x32_bf16 v[64:67], v[28:31], v[192:195], v[64:67]
ds_read_b64_tr_b16 v[46:47], v168 offset:33792
s_waitcnt lgkmcnt(6)
v_mfma_f32_16x16x32_bf16 v[68:71], v[32:35], v[188:191], v[68:71]
ds_read_b64_tr_b16 v[48:49], v169 offset:32768
v_mfma_f32_16x16x32_bf16 v[72:75], v[32:35], v[192:195], v[72:75]
ds_read_b64_tr_b16 v[50:51], v169 offset:33792
s_waitcnt lgkmcnt(6)
v_mfma_f32_16x16x32_bf16 v[76:79], v[36:39], v[188:191], v[76:79]
ds_read_b64_tr_b16 v[52:53], v170 offset:32768
v_mfma_f32_16x16x32_bf16 v[80:83], v[36:39], v[192:195], v[80:83]
ds_read_b64_tr_b16 v[54:55], v170 offset:33792
ds_read_b128 v[196:199], v183 offset:32768
s_waitcnt lgkmcnt(7)
v_mfma_f32_16x16x32_bf16 v[84:87], v[40:43], v[188:191], v[84:87]
ds_read_b64_tr_b16 v[56:57], v171 offset:32768
v_mfma_f32_16x16x32_bf16 v[88:91], v[40:43], v[192:195], v[88:91]
ds_read_b64_tr_b16 v[58:59], v171 offset:33792
ds_read_b128 v[200:203], v183 offset:34816
s_waitcnt lgkmcnt(8)
v_mfma_f32_16x16x32_bf16 v[92:95], v[44:47], v[188:191], v[92:95]
ds_read_b64_tr_b16 v[28:29], v164 offset:40960
v_mfma_f32_16x16x32_bf16 v[96:99], v[44:47], v[192:195], v[96:99]
ds_read_b64_tr_b16 v[30:31], v164 offset:41984
s_waitcnt lgkmcnt(8)
v_mfma_f32_16x16x32_bf16 v[100:103], v[48:51], v[188:191], v[100:103]
ds_read_b64_tr_b16 v[32:33], v165 offset:40960
v_mfma_f32_16x16x32_bf16 v[104:107], v[48:51], v[192:195], v[104:107]
ds_read_b64_tr_b16 v[34:35], v165 offset:41984
s_waitcnt lgkmcnt(8)
v_mfma_f32_16x16x32_bf16 v[108:111], v[52:55], v[188:191], v[108:111]
ds_read_b64_tr_b16 v[36:37], v166 offset:40960
v_mfma_f32_16x16x32_bf16 v[112:115], v[52:55], v[192:195], v[112:115]
ds_read_b64_tr_b16 v[38:39], v166 offset:41984
s_waitcnt lgkmcnt(7)
v_mfma_f32_16x16x32_bf16 v[116:119], v[56:59], v[188:191], v[116:119]
ds_read_b64_tr_b16 v[40:41], v167 offset:40960
v_mfma_f32_16x16x32_bf16 v[120:123], v[56:59], v[192:195], v[120:123]
ds_read_b64_tr_b16 v[42:43], v167 offset:41984
s_waitcnt lgkmcnt(6)
v_mfma_f32_16x16x32_bf16 v[60:63], v[28:31], v[196:199], v[60:63]
ds_read_b64_tr_b16 v[44:45], v168 offset:40960
v_mfma_f32_16x16x32_bf16 v[64:67], v[28:31], v[200:203], v[64:67]
ds_read_b64_tr_b16 v[46:47], v168 offset:41984
s_waitcnt lgkmcnt(6)
v_mfma_f32_16x16x32_bf16 v[68:71], v[32:35], v[196:199], v[68:71]
ds_read_b64_tr_b16 v[48:49], v169 offset:40960
v_mfma_f32_16x16x32_bf16 v[72:75], v[32:35], v[200:203], v[72:75]
ds_read_b64_tr_b16 v[50:51], v169 offset:41984
s_waitcnt lgkmcnt(6)
v_mfma_f32_16x16x32_bf16 v[76:79], v[36:39], v[196:199], v[76:79]
ds_read_b64_tr_b16 v[52:53], v170 offset:40960
v_mfma_f32_16x16x32_bf16 v[80:83], v[36:39], v[200:203], v[80:83]
ds_read_b64_tr_b16 v[54:55], v170 offset:41984
s_waitcnt lgkmcnt(6)
v_mfma_f32_16x16x32_bf16 v[84:87], v[40:43], v[196:199], v[84:87]
ds_read_b64_tr_b16 v[56:57], v171 offset:40960
v_mfma_f32_16x16x32_bf16 v[88:91], v[40:43], v[200:203], v[88:91]
ds_read_b64_tr_b16 v[58:59], v171 offset:41984
s_waitcnt lgkmcnt(6)
v_mfma_f32_16x16x32_bf16 v[92:95], v[44:47], v[196:199], v[92:95]
v_mfma_f32_16x16x32_bf16 v[96:99], v[44:47], v[200:203], v[96:99]
s_waitcnt lgkmcnt(4)
v_mfma_f32_16x16x32_bf16 v[100:103], v[48:51], v[196:199], v[100:103]
v_mfma_f32_16x16x32_bf16 v[104:107], v[48:51], v[200:203], v[104:107]
s_waitcnt lgkmcnt(0)
s_barrier
ds_read_b128 v[188:191], v184 offset:0
ds_read_b128 v[192:195], v184 offset:2048
ds_read_b64_tr_b16 v[28:29], v172 offset:0
ds_read_b64_tr_b16 v[30:31], v172 offset:1024
ds_read_b64_tr_b16 v[32:33], v173 offset:0
ds_read_b64_tr_b16 v[34:35], v173 offset:1024
v_mfma_f32_16x16x32_bf16 v[108:111], v[52:55], v[196:199], v[108:111]
ds_read_b64_tr_b16 v[36:37], v174 offset:0
v_mfma_f32_16x16x32_bf16 v[112:115], v[52:55], v[200:203], v[112:115]
ds_read_b64_tr_b16 v[38:39], v174 offset:1024
v_mfma_f32_16x16x32_bf16 v[116:119], v[56:59], v[196:199], v[116:119]
ds_read_b64_tr_b16 v[40:41], v175 offset:0
v_mfma_f32_16x16x32_bf16 v[120:123], v[56:59], v[200:203], v[120:123]
ds_read_b64_tr_b16 v[42:43], v175 offset:1024
s_waitcnt lgkmcnt(6)
v_mfma_f32_16x16x32_bf16 v[60:63], v[28:31], v[188:191], v[60:63]
ds_read_b64_tr_b16 v[44:45], v176 offset:0
v_mfma_f32_16x16x32_bf16 v[64:67], v[28:31], v[192:195], v[64:67]
ds_read_b64_tr_b16 v[46:47], v176 offset:1024
s_waitcnt lgkmcnt(6)
v_mfma_f32_16x16x32_bf16 v[68:71], v[32:35], v[188:191], v[68:71]
ds_read_b64_tr_b16 v[48:49], v177 offset:0
v_mfma_f32_16x16x32_bf16 v[72:75], v[32:35], v[192:195], v[72:75]
ds_read_b64_tr_b16 v[50:51], v177 offset:1024
s_waitcnt lgkmcnt(6)
v_mfma_f32_16x16x32_bf16 v[76:79], v[36:39], v[188:191], v[76:79]
ds_read_b64_tr_b16 v[52:53], v178 offset:0
v_mfma_f32_16x16x32_bf16 v[80:83], v[36:39], v[192:195], v[80:83]
ds_read_b64_tr_b16 v[54:55], v178 offset:1024
ds_read_b128 v[196:199], v185 offset:0
s_waitcnt lgkmcnt(7)
v_mfma_f32_16x16x32_bf16 v[84:87], v[40:43], v[188:191], v[84:87]
ds_read_b64_tr_b16 v[56:57], v179 offset:0
v_mfma_f32_16x16x32_bf16 v[88:91], v[40:43], v[192:195], v[88:91]
ds_read_b64_tr_b16 v[58:59], v179 offset:1024
ds_read_b128 v[200:203], v185 offset:2048
s_waitcnt lgkmcnt(8)
v_mfma_f32_16x16x32_bf16 v[92:95], v[44:47], v[188:191], v[92:95]
ds_read_b64_tr_b16 v[28:29], v172 offset:8192
v_mfma_f32_16x16x32_bf16 v[96:99], v[44:47], v[192:195], v[96:99]
ds_read_b64_tr_b16 v[30:31], v172 offset:9216
s_waitcnt lgkmcnt(8)
v_mfma_f32_16x16x32_bf16 v[100:103], v[48:51], v[188:191], v[100:103]
ds_read_b64_tr_b16 v[32:33], v173 offset:8192
v_mfma_f32_16x16x32_bf16 v[104:107], v[48:51], v[192:195], v[104:107]
ds_read_b64_tr_b16 v[34:35], v173 offset:9216
s_waitcnt lgkmcnt(8)
v_mfma_f32_16x16x32_bf16 v[108:111], v[52:55], v[188:191], v[108:111]
ds_read_b64_tr_b16 v[36:37], v174 offset:8192
v_mfma_f32_16x16x32_bf16 v[112:115], v[52:55], v[192:195], v[112:115]
ds_read_b64_tr_b16 v[38:39], v174 offset:9216
s_waitcnt lgkmcnt(7)
v_mfma_f32_16x16x32_bf16 v[116:119], v[56:59], v[188:191], v[116:119]
ds_read_b64_tr_b16 v[40:41], v175 offset:8192
v_mfma_f32_16x16x32_bf16 v[120:123], v[56:59], v[192:195], v[120:123]
ds_read_b64_tr_b16 v[42:43], v175 offset:9216
s_waitcnt lgkmcnt(6)
v_mfma_f32_16x16x32_bf16 v[60:63], v[28:31], v[196:199], v[60:63]
ds_read_b64_tr_b16 v[44:45], v176 offset:8192
v_mfma_f32_16x16x32_bf16 v[64:67], v[28:31], v[200:203], v[64:67]
ds_read_b64_tr_b16 v[46:47], v176 offset:9216
s_waitcnt lgkmcnt(6)
v_mfma_f32_16x16x32_bf16 v[68:71], v[32:35], v[196:199], v[68:71]
ds_read_b64_tr_b16 v[48:49], v177 offset:8192
v_mfma_f32_16x16x32_bf16 v[72:75], v[32:35], v[200:203], v[72:75]
ds_read_b64_tr_b16 v[50:51], v177 offset:9216
s_waitcnt lgkmcnt(6)
v_mfma_f32_16x16x32_bf16 v[76:79], v[36:39], v[196:199], v[76:79]
ds_read_b64_tr_b16 v[52:53], v178 offset:8192
v_mfma_f32_16x16x32_bf16 v[80:83], v[36:39], v[200:203], v[80:83]
ds_read_b64_tr_b16 v[54:55], v178 offset:9216
s_waitcnt lgkmcnt(6)
v_mfma_f32_16x16x32_bf16 v[84:87], v[40:43], v[196:199], v[84:87]
ds_read_b64_tr_b16 v[56:57], v179 offset:8192
v_mfma_f32_16x16x32_bf16 v[88:91], v[40:43], v[200:203], v[88:91]
ds_read_b64_tr_b16 v[58:59], v179 offset:9216
s_waitcnt lgkmcnt(6)
v_mfma_f32_16x16x32_bf16 v[92:95], v[44:47], v[196:199], v[92:95]
v_mfma_f32_16x16x32_bf16 v[96:99], v[44:47], v[200:203], v[96:99]
s_waitcnt lgkmcnt(4)
v_mfma_f32_16x16x32_bf16 v[100:103], v[48:51], v[196:199], v[100:103]
v_mfma_f32_16x16x32_bf16 v[104:107], v[48:51], v[200:203], v[104:107]
s_waitcnt lgkmcnt(0)
s_barrier
ds_read_b128 v[188:191], v180 offset:0
ds_read_b128 v[192:195], v180 offset:2048
ds_read_b64_tr_b16 v[28:29], v156 offset:0
ds_read_b64_tr_b16 v[30:31], v156 offset:1024
ds_read_b64_tr_b16 v[32:33], v157 offset:0
ds_read_b64_tr_b16 v[34:35], v157 offset:1024
v_mfma_f32_16x16x32_bf16 v[108:111], v[52:55], v[196:199], v[108:111]
ds_read_b64_tr_b16 v[36:37], v158 offset:0
v_mfma_f32_16x16x32_bf16 v[112:115], v[52:55], v[200:203], v[112:115]
ds_read_b64_tr_b16 v[38:39], v158 offset:1024
v_mfma_f32_16x16x32_bf16 v[116:119], v[56:59], v[196:199], v[116:119]
ds_read_b64_tr_b16 v[40:41], v159 offset:0
v_mfma_f32_16x16x32_bf16 v[120:123], v[56:59], v[200:203], v[120:123]
ds_read_b64_tr_b16 v[42:43], v159 offset:1024
buffer_load_dword v12, v14, s[68:71], s75 offen sc1
s_waitcnt lgkmcnt(6)
v_mfma_f32_16x16x32_bf16 v[60:63], v[28:31], v[188:191], v[60:63]
ds_read_b64_tr_b16 v[44:45], v160 offset:0
v_mfma_f32_16x16x32_bf16 v[64:67], v[28:31], v[192:195], v[64:67]
ds_read_b64_tr_b16 v[46:47], v160 offset:1024
s_waitcnt lgkmcnt(6)
v_mfma_f32_16x16x32_bf16 v[68:71], v[32:35], v[188:191], v[68:71]
ds_read_b64_tr_b16 v[48:49], v161 offset:0
v_mfma_f32_16x16x32_bf16 v[72:75], v[32:35], v[192:195], v[72:75]
ds_read_b64_tr_b16 v[50:51], v161 offset:1024
s_waitcnt lgkmcnt(6)
v_mfma_f32_16x16x32_bf16 v[76:79], v[36:39], v[188:191], v[76:79]
ds_read_b64_tr_b16 v[52:53], v162 offset:0
v_mfma_f32_16x16x32_bf16 v[80:83], v[36:39], v[192:195], v[80:83]
ds_read_b64_tr_b16 v[54:55], v162 offset:1024
ds_read_b128 v[196:199], v181 offset:0
s_waitcnt lgkmcnt(7)
v_mfma_f32_16x16x32_bf16 v[84:87], v[40:43], v[188:191], v[84:87]
ds_read_b64_tr_b16 v[56:57], v163 offset:0
v_mfma_f32_16x16x32_bf16 v[88:91], v[40:43], v[192:195], v[88:91]
ds_read_b64_tr_b16 v[58:59], v163 offset:1024
ds_read_b128 v[200:203], v181 offset:2048
s_waitcnt lgkmcnt(8)
v_mfma_f32_16x16x32_bf16 v[92:95], v[44:47], v[188:191], v[92:95]
ds_read_b64_tr_b16 v[28:29], v156 offset:8192
v_mfma_f32_16x16x32_bf16 v[96:99], v[44:47], v[192:195], v[96:99]
ds_read_b64_tr_b16 v[30:31], v156 offset:9216
s_waitcnt lgkmcnt(8)
v_mfma_f32_16x16x32_bf16 v[100:103], v[48:51], v[188:191], v[100:103]
ds_read_b64_tr_b16 v[32:33], v157 offset:8192
v_mfma_f32_16x16x32_bf16 v[104:107], v[48:51], v[192:195], v[104:107]
ds_read_b64_tr_b16 v[34:35], v157 offset:9216
s_waitcnt lgkmcnt(8)
v_mfma_f32_16x16x32_bf16 v[108:111], v[52:55], v[188:191], v[108:111]
ds_read_b64_tr_b16 v[36:37], v158 offset:8192
v_mfma_f32_16x16x32_bf16 v[112:115], v[52:55], v[192:195], v[112:115]
ds_read_b64_tr_b16 v[38:39], v158 offset:9216
s_waitcnt lgkmcnt(7)
v_mfma_f32_16x16x32_bf16 v[116:119], v[56:59], v[188:191], v[116:119]
ds_read_b64_tr_b16 v[40:41], v159 offset:8192
v_mfma_f32_16x16x32_bf16 v[120:123], v[56:59], v[192:195], v[120:123]
ds_read_b64_tr_b16 v[42:43], v159 offset:9216
s_waitcnt lgkmcnt(6)
v_mfma_f32_16x16x32_bf16 v[60:63], v[28:31], v[196:199], v[60:63]
ds_read_b64_tr_b16 v[44:45], v160 offset:8192
v_mfma_f32_16x16x32_bf16 v[64:67], v[28:31], v[200:203], v[64:67]
ds_read_b64_tr_b16 v[46:47], v160 offset:9216
s_waitcnt lgkmcnt(6)
v_mfma_f32_16x16x32_bf16 v[68:71], v[32:35], v[196:199], v[68:71]
ds_read_b64_tr_b16 v[48:49], v161 offset:8192
v_mfma_f32_16x16x32_bf16 v[72:75], v[32:35], v[200:203], v[72:75]
ds_read_b64_tr_b16 v[50:51], v161 offset:9216
s_waitcnt lgkmcnt(6)
v_mfma_f32_16x16x32_bf16 v[76:79], v[36:39], v[196:199], v[76:79]
ds_read_b64_tr_b16 v[52:53], v162 offset:8192
v_mfma_f32_16x16x32_bf16 v[80:83], v[36:39], v[200:203], v[80:83]
ds_read_b64_tr_b16 v[54:55], v162 offset:9216
s_waitcnt lgkmcnt(6)
v_mfma_f32_16x16x32_bf16 v[84:87], v[40:43], v[196:199], v[84:87]
ds_read_b64_tr_b16 v[56:57], v163 offset:8192
v_mfma_f32_16x16x32_bf16 v[88:91], v[40:43], v[200:203], v[88:91]
ds_read_b64_tr_b16 v[58:59], v163 offset:9216
s_waitcnt lgkmcnt(6)
v_mfma_f32_16x16x32_bf16 v[92:95], v[44:47], v[196:199], v[92:95]
v_mfma_f32_16x16x32_bf16 v[96:99], v[44:47], v[200:203], v[96:99]
s_waitcnt lgkmcnt(4)
v_mfma_f32_16x16x32_bf16 v[100:103], v[48:51], v[196:199], v[100:103]
v_mfma_f32_16x16x32_bf16 v[104:107], v[48:51], v[200:203], v[104:107]
s_waitcnt lgkmcnt(0)
s_barrier
ds_read_b128 v[188:191], v180 offset:32768
ds_read_b128 v[192:195], v180 offset:34816
ds_read_b64_tr_b16 v[28:29], v156 offset:32768
ds_read_b64_tr_b16 v[30:31], v156 offset:33792
ds_read_b64_tr_b16 v[32:33], v157 offset:32768
ds_read_b64_tr_b16 v[34:35], v157 offset:33792
v_mfma_f32_16x16x32_bf16 v[108:111], v[52:55], v[196:199], v[108:111]
ds_read_b64_tr_b16 v[36:37], v158 offset:32768
v_mfma_f32_16x16x32_bf16 v[112:115], v[52:55], v[200:203], v[112:115]
ds_read_b64_tr_b16 v[38:39], v158 offset:33792
v_mfma_f32_16x16x32_bf16 v[116:119], v[56:59], v[196:199], v[116:119]
ds_read_b64_tr_b16 v[40:41], v159 offset:32768
v_mfma_f32_16x16x32_bf16 v[120:123], v[56:59], v[200:203], v[120:123]
ds_read_b64_tr_b16 v[42:43], v159 offset:33792
s_waitcnt lgkmcnt(6)
v_mfma_f32_16x16x32_bf16 v[60:63], v[28:31], v[188:191], v[60:63]
ds_read_b64_tr_b16 v[44:45], v160 offset:32768
v_mfma_f32_16x16x32_bf16 v[64:67], v[28:31], v[192:195], v[64:67]
ds_read_b64_tr_b16 v[46:47], v160 offset:33792
s_waitcnt lgkmcnt(6)
v_mfma_f32_16x16x32_bf16 v[68:71], v[32:35], v[188:191], v[68:71]
ds_read_b64_tr_b16 v[48:49], v161 offset:32768
v_mfma_f32_16x16x32_bf16 v[72:75], v[32:35], v[192:195], v[72:75]
ds_read_b64_tr_b16 v[50:51], v161 offset:33792
s_waitcnt lgkmcnt(6)
v_mfma_f32_16x16x32_bf16 v[76:79], v[36:39], v[188:191], v[76:79]
ds_read_b64_tr_b16 v[52:53], v162 offset:32768
v_mfma_f32_16x16x32_bf16 v[80:83], v[36:39], v[192:195], v[80:83]
ds_read_b64_tr_b16 v[54:55], v162 offset:33792
ds_read_b128 v[196:199], v181 offset:32768
s_waitcnt lgkmcnt(7)
v_mfma_f32_16x16x32_bf16 v[84:87], v[40:43], v[188:191], v[84:87]
ds_read_b64_tr_b16 v[56:57], v163 offset:32768
v_mfma_f32_16x16x32_bf16 v[88:91], v[40:43], v[192:195], v[88:91]
ds_read_b64_tr_b16 v[58:59], v163 offset:33792
ds_read_b128 v[200:203], v181 offset:34816
s_waitcnt lgkmcnt(8)
v_mfma_f32_16x16x32_bf16 v[92:95], v[44:47], v[188:191], v[92:95]
ds_read_b64_tr_b16 v[28:29], v156 offset:40960
v_mfma_f32_16x16x32_bf16 v[96:99], v[44:47], v[192:195], v[96:99]
ds_read_b64_tr_b16 v[30:31], v156 offset:41984
s_waitcnt lgkmcnt(8)
v_mfma_f32_16x16x32_bf16 v[100:103], v[48:51], v[188:191], v[100:103]
ds_read_b64_tr_b16 v[32:33], v157 offset:40960
v_mfma_f32_16x16x32_bf16 v[104:107], v[48:51], v[192:195], v[104:107]
ds_read_b64_tr_b16 v[34:35], v157 offset:41984
s_waitcnt lgkmcnt(8)
v_mfma_f32_16x16x32_bf16 v[108:111], v[52:55], v[188:191], v[108:111]
ds_read_b64_tr_b16 v[36:37], v158 offset:40960
v_mfma_f32_16x16x32_bf16 v[112:115], v[52:55], v[192:195], v[112:115]
ds_read_b64_tr_b16 v[38:39], v158 offset:41984
s_waitcnt lgkmcnt(7)
v_mfma_f32_16x16x32_bf16 v[116:119], v[56:59], v[188:191], v[116:119]
ds_read_b64_tr_b16 v[40:41], v159 offset:40960
v_mfma_f32_16x16x32_bf16 v[120:123], v[56:59], v[192:195], v[120:123]
ds_read_b64_tr_b16 v[42:43], v159 offset:41984
s_waitcnt lgkmcnt(6)
v_mfma_f32_16x16x32_bf16 v[60:63], v[28:31], v[196:199], v[60:63]
ds_read_b64_tr_b16 v[44:45], v160 offset:40960
v_mfma_f32_16x16x32_bf16 v[64:67], v[28:31], v[200:203], v[64:67]
ds_read_b64_tr_b16 v[46:47], v160 offset:41984
s_waitcnt lgkmcnt(6)
v_mfma_f32_16x16x32_bf16 v[68:71], v[32:35], v[196:199], v[68:71]
ds_read_b64_tr_b16 v[48:49], v161 offset:40960
v_mfma_f32_16x16x32_bf16 v[72:75], v[32:35], v[200:203], v[72:75]
ds_read_b64_tr_b16 v[50:51], v161 offset:41984
s_waitcnt lgkmcnt(6)
v_mfma_f32_16x16x32_bf16 v[76:79], v[36:39], v[196:199], v[76:79]
ds_read_b64_tr_b16 v[52:53], v162 offset:40960
v_mfma_f32_16x16x32_bf16 v[80:83], v[36:39], v[200:203], v[80:83]
ds_read_b64_tr_b16 v[54:55], v162 offset:41984
s_waitcnt lgkmcnt(6)
v_mfma_f32_16x16x32_bf16 v[84:87], v[40:43], v[196:199], v[84:87]
ds_read_b64_tr_b16 v[56:57], v163 offset:40960
v_mfma_f32_16x16x32_bf16 v[88:91], v[40:43], v[200:203], v[88:91]
ds_read_b64_tr_b16 v[58:59], v163 offset:41984
s_waitcnt lgkmcnt(6)
v_mfma_f32_16x16x32_bf16 v[92:95], v[44:47], v[196:199], v[92:95]
v_mfma_f32_16x16x32_bf16 v[96:99], v[44:47], v[200:203], v[96:99]
s_waitcnt lgkmcnt(4)
v_mfma_f32_16x16x32_bf16 v[100:103], v[48:51], v[196:199], v[100:103]
v_mfma_f32_16x16x32_bf16 v[104:107], v[48:51], v[200:203], v[104:107]
s_waitcnt lgkmcnt(0)
s_barrier
ds_read_b128 v[188:191], v182 offset:0
ds_read_b128 v[192:195], v182 offset:2048
ds_read_b64_tr_b16 v[28:29], v164 offset:0
ds_read_b64_tr_b16 v[30:31], v164 offset:1024
ds_read_b64_tr_b16 v[32:33], v165 offset:0
ds_read_b64_tr_b16 v[34:35], v165 offset:1024
v_mfma_f32_16x16x32_bf16 v[108:111], v[52:55], v[196:199], v[108:111]
ds_read_b64_tr_b16 v[36:37], v166 offset:0
v_mfma_f32_16x16x32_bf16 v[112:115], v[52:55], v[200:203], v[112:115]
ds_read_b64_tr_b16 v[38:39], v166 offset:1024
v_mfma_f32_16x16x32_bf16 v[116:119], v[56:59], v[196:199], v[116:119]
ds_read_b64_tr_b16 v[40:41], v167 offset:0
v_mfma_f32_16x16x32_bf16 v[120:123], v[56:59], v[200:203], v[120:123]
ds_read_b64_tr_b16 v[42:43], v167 offset:1024
s_waitcnt lgkmcnt(6)
v_mfma_f32_16x16x32_bf16 v[60:63], v[28:31], v[188:191], v[60:63]
ds_read_b64_tr_b16 v[44:45], v168 offset:0
v_mfma_f32_16x16x32_bf16 v[64:67], v[28:31], v[192:195], v[64:67]
ds_read_b64_tr_b16 v[46:47], v168 offset:1024
s_waitcnt lgkmcnt(6)
v_mfma_f32_16x16x32_bf16 v[68:71], v[32:35], v[188:191], v[68:71]
ds_read_b64_tr_b16 v[48:49], v169 offset:0
v_mfma_f32_16x16x32_bf16 v[72:75], v[32:35], v[192:195], v[72:75]
ds_read_b64_tr_b16 v[50:51], v169 offset:1024
s_waitcnt lgkmcnt(6)
v_mfma_f32_16x16x32_bf16 v[76:79], v[36:39], v[188:191], v[76:79]
ds_read_b64_tr_b16 v[52:53], v170 offset:0
v_mfma_f32_16x16x32_bf16 v[80:83], v[36:39], v[192:195], v[80:83]
ds_read_b64_tr_b16 v[54:55], v170 offset:1024
ds_read_b128 v[196:199], v183 offset:0
s_waitcnt lgkmcnt(7)
v_mfma_f32_16x16x32_bf16 v[84:87], v[40:43], v[188:191], v[84:87]
ds_read_b64_tr_b16 v[56:57], v171 offset:0
v_mfma_f32_16x16x32_bf16 v[88:91], v[40:43], v[192:195], v[88:91]
ds_read_b64_tr_b16 v[58:59], v171 offset:1024
ds_read_b128 v[200:203], v183 offset:2048
s_waitcnt lgkmcnt(8)
v_mfma_f32_16x16x32_bf16 v[92:95], v[44:47], v[188:191], v[92:95]
ds_read_b64_tr_b16 v[28:29], v164 offset:8192
v_mfma_f32_16x16x32_bf16 v[96:99], v[44:47], v[192:195], v[96:99]
ds_read_b64_tr_b16 v[30:31], v164 offset:9216
s_waitcnt lgkmcnt(8)
v_mfma_f32_16x16x32_bf16 v[100:103], v[48:51], v[188:191], v[100:103]
ds_read_b64_tr_b16 v[32:33], v165 offset:8192
v_mfma_f32_16x16x32_bf16 v[104:107], v[48:51], v[192:195], v[104:107]
ds_read_b64_tr_b16 v[34:35], v165 offset:9216
s_waitcnt lgkmcnt(8)
v_mfma_f32_16x16x32_bf16 v[108:111], v[52:55], v[188:191], v[108:111]
ds_read_b64_tr_b16 v[36:37], v166 offset:8192
v_mfma_f32_16x16x32_bf16 v[112:115], v[52:55], v[192:195], v[112:115]
ds_read_b64_tr_b16 v[38:39], v166 offset:9216
s_waitcnt lgkmcnt(7)
v_mfma_f32_16x16x32_bf16 v[116:119], v[56:59], v[188:191], v[116:119]
ds_read_b64_tr_b16 v[40:41], v167 offset:8192
v_mfma_f32_16x16x32_bf16 v[120:123], v[56:59], v[192:195], v[120:123]
ds_read_b64_tr_b16 v[42:43], v167 offset:9216
s_waitcnt lgkmcnt(6)
v_mfma_f32_16x16x32_bf16 v[60:63], v[28:31], v[196:199], v[60:63]
ds_read_b64_tr_b16 v[44:45], v168 offset:8192
v_mfma_f32_16x16x32_bf16 v[64:67], v[28:31], v[200:203], v[64:67]
ds_read_b64_tr_b16 v[46:47], v168 offset:9216
s_waitcnt lgkmcnt(6)
v_mfma_f32_16x16x32_bf16 v[68:71], v[32:35], v[196:199], v[68:71]
ds_read_b64_tr_b16 v[48:49], v169 offset:8192
v_mfma_f32_16x16x32_bf16 v[72:75], v[32:35], v[200:203], v[72:75]
ds_read_b64_tr_b16 v[50:51], v169 offset:9216
s_waitcnt lgkmcnt(6)
v_mfma_f32_16x16x32_bf16 v[76:79], v[36:39], v[196:199], v[76:79]
ds_read_b64_tr_b16 v[52:53], v170 offset:8192
v_mfma_f32_16x16x32_bf16 v[80:83], v[36:39], v[200:203], v[80:83]
ds_read_b64_tr_b16 v[54:55], v170 offset:9216
s_waitcnt lgkmcnt(6)
v_mfma_f32_16x16x32_bf16 v[84:87], v[40:43], v[196:199], v[84:87]
ds_read_b64_tr_b16 v[56:57], v171 offset:8192
v_mfma_f32_16x16x32_bf16 v[88:91], v[40:43], v[200:203], v[88:91]
ds_read_b64_tr_b16 v[58:59], v171 offset:9216
s_waitcnt lgkmcnt(6)
v_mfma_f32_16x16x32_bf16 v[92:95], v[44:47], v[196:199], v[92:95]
v_mfma_f32_16x16x32_bf16 v[96:99], v[44:47], v[200:203], v[96:99]
s_waitcnt lgkmcnt(4)
v_mfma_f32_16x16x32_bf16 v[100:103], v[48:51], v[196:199], v[100:103]
v_mfma_f32_16x16x32_bf16 v[104:107], v[48:51], v[200:203], v[104:107]
s_waitcnt lgkmcnt(0)
s_barrier
ds_read_b64 v[156:157], v220 offset:0
ds_read_b64 v[158:159], v221 offset:0
ds_read_b64 v[172:173], v220 offset:4096
ds_read_b64 v[174:175], v221 offset:4096
v_mfma_f32_16x16x32_bf16 v[108:111], v[52:55], v[196:199], v[108:111]
ds_read_b64 v[160:161], v222 offset:0
ds_read_b64 v[162:163], v223 offset:0
ds_read_b64 v[176:177], v222 offset:4096
v_mfma_f32_16x16x32_bf16 v[112:115], v[52:55], v[200:203], v[112:115]
ds_read_b64 v[178:179], v223 offset:4096
ds_read_b64 v[164:165], v224 offset:0
ds_read_b64 v[166:167], v225 offset:0
v_mfma_f32_16x16x32_bf16 v[116:119], v[56:59], v[196:199], v[116:119]
ds_read_b64 v[180:181], v224 offset:4096
ds_read_b64 v[182:183], v225 offset:4096
ds_read_b64 v[168:169], v226 offset:0
v_mfma_f32_16x16x32_bf16 v[120:123], v[56:59], v[200:203], v[120:123]
ds_read_b64 v[170:171], v227 offset:0
ds_read_b64 v[184:185], v226 offset:4096
ds_read_b64 v[186:187], v227 offset:4096
v_cvt_pk_bf16_f32 v124, v60, v61
v_cvt_pk_bf16_f32 v125, v62, v63
v_cvt_pk_bf16_f32 v126, v68, v69
v_cvt_pk_bf16_f32 v127, v70, v71
v_cvt_pk_bf16_f32 v128, v64, v65
v_cvt_pk_bf16_f32 v129, v66, v67
v_cvt_pk_bf16_f32 v130, v72, v73
v_cvt_pk_bf16_f32 v131, v74, v75
s_waitcnt lgkmcnt(12)
s_nop 0
v_mfma_f32_16x16x32_bf16 v[28:31], v[156:159], v[124:127], 0
v_mfma_f32_16x16x32_bf16 v[36:39], v[156:159], v[128:131], 0
v_mfma_f32_16x16x32_bf16 v[32:35], v[172:175], v[124:127], 0
v_mfma_f32_16x16x32_bf16 v[40:43], v[172:175], v[128:131], 0
v_cvt_pk_bf16_f32 v132, v76, v77
v_cvt_pk_bf16_f32 v133, v78, v79
v_cvt_pk_bf16_f32 v134, v84, v85
v_cvt_pk_bf16_f32 v135, v86, v87
v_cvt_pk_bf16_f32 v136, v80, v81
v_cvt_pk_bf16_f32 v137, v82, v83
v_cvt_pk_bf16_f32 v138, v88, v89
v_cvt_pk_bf16_f32 v139, v90, v91
s_waitcnt lgkmcnt(8)
s_nop 0
v_mfma_f32_16x16x32_bf16 v[28:31], v[160:163], v[132:135], v[28:31]
v_mfma_f32_16x16x32_bf16 v[36:39], v[160:163], v[136:139], v[36:39]
v_mfma_f32_16x16x32_bf16 v[32:35], v[176:179], v[132:135], v[32:35]
v_mfma_f32_16x16x32_bf16 v[40:43], v[176:179], v[136:139], v[40:43]
v_cvt_pk_bf16_f32 v140, v92, v93
v_cvt_pk_bf16_f32 v141, v94, v95
v_cvt_pk_bf16_f32 v142, v100, v101
v_cvt_pk_bf16_f32 v143, v102, v103
v_cvt_pk_bf16_f32 v144, v96, v97
v_cvt_pk_bf16_f32 v145, v98, v99
v_cvt_pk_bf16_f32 v146, v104, v105
v_cvt_pk_bf16_f32 v147, v106, v107
s_waitcnt lgkmcnt(4)
s_nop 0
v_mfma_f32_16x16x32_bf16 v[28:31], v[164:167], v[140:143], v[28:31]
v_mfma_f32_16x16x32_bf16 v[36:39], v[164:167], v[144:147], v[36:39]
v_mfma_f32_16x16x32_bf16 v[32:35], v[180:183], v[140:143], v[32:35]
v_mfma_f32_16x16x32_bf16 v[40:43], v[180:183], v[144:147], v[40:43]
v_cvt_pk_bf16_f32 v148, v108, v109
v_cvt_pk_bf16_f32 v149, v110, v111
v_cvt_pk_bf16_f32 v150, v116, v117
v_cvt_pk_bf16_f32 v151, v118, v119
v_cvt_pk_bf16_f32 v152, v112, v113
v_cvt_pk_bf16_f32 v153, v114, v115
v_cvt_pk_bf16_f32 v154, v120, v121
v_cvt_pk_bf16_f32 v155, v122, v123
s_waitcnt lgkmcnt(0)
s_nop 0
v_mfma_f32_16x16x32_bf16 v[28:31], v[168:171], v[148:151], v[28:31]
v_mfma_f32_16x16x32_bf16 v[36:39], v[168:171], v[152:155], v[36:39]
v_mfma_f32_16x16x32_bf16 v[32:35], v[184:187], v[148:151], v[32:35]
v_mfma_f32_16x16x32_bf16 v[40:43], v[184:187], v[152:155], v[40:43]
s_barrier
ds_read_b64_tr_b16 v[188:189], v228 offset:0
ds_read_b64_tr_b16 v[190:191], v228 offset:4096
ds_read_b64_tr_b16 v[192:193], v229 offset:0
ds_read_b64_tr_b16 v[194:195], v229 offset:4096
ds_read_b64_tr_b16 v[196:197], v230 offset:0
ds_read_b64_tr_b16 v[198:199], v230 offset:4096
ds_read_b64_tr_b16 v[200:201], v231 offset:0
ds_read_b64_tr_b16 v[202:203], v231 offset:4096
ds_read_b64_tr_b16 v[204:205], v232 offset:0
ds_read_b64_tr_b16 v[206:207], v232 offset:4096
ds_read_b64_tr_b16 v[208:209], v233 offset:0
ds_read_b64_tr_b16 v[210:211], v233 offset:4096
ds_read_b64_tr_b16 v[212:213], v234 offset:0
ds_read_b64_tr_b16 v[214:215], v234 offset:4096
ds_read_b64_tr_b16 v[216:217], v235 offset:0
ds_read_b64_tr_b16 v[218:219], v235 offset:4096
v_max3_f32 v2, v28, v29, v30
v_max3_f32 v3, v36, v37, v38
v_max3_f32 v4, v31, v32, v33
v_max3_f32 v5, v39, v40, v41
v_max3_f32 v2, v2, v34, v35
v_max3_f32 v3, v3, v42, v43
v_max_f32 v2, v2, v4
v_max_f32 v3, v3, v5
s_nop 0
s_nop 0
v_permlane32_swap_b32 v2, v3
s_nop 1
v_max_f32 v2, v2, v3
v_mov_b32 v3, v2
s_nop 1
v_permlane16_swap_b32 v2, v3
s_nop 1
v_max_f32 v2, v2, v3
v_mul_f32 v2, s86, v2
v_mov_b32 v3, v2
s_nop 1
v_permlane32_swap_b32 v2, v3
s_nop 1
v_fma_f32 v28, v28, s86, -v2
v_fma_f32 v29, v29, s86, -v2
v_fma_f32 v30, v30, s86, -v2
v_fma_f32 v31, v31, s86, -v2
v_fma_f32 v32, v32, s86, -v2
v_fma_f32 v33, v33, s86, -v2
v_fma_f32 v34, v34, s86, -v2
v_fma_f32 v35, v35, s86, -v2
v_fma_f32 v36, v36, s86, -v3
v_fma_f32 v37, v37, s86, -v3
v_fma_f32 v38, v38, s86, -v3
v_fma_f32 v39, v39, s86, -v3
v_fma_f32 v40, v40, s86, -v3
v_fma_f32 v41, v41, s86, -v3
v_fma_f32 v42, v42, s86, -v3
v_fma_f32 v43, v43, s86, -v3
v_exp_f32 v28, v28
v_exp_f32 v29, v29
v_exp_f32 v30, v30
v_exp_f32 v31, v31
v_exp_f32 v32, v32
v_exp_f32 v33, v33
v_exp_f32 v34, v34
v_exp_f32 v35, v35
v_exp_f32 v36, v36
v_exp_f32 v37, v37
v_exp_f32 v38, v38
v_exp_f32 v39, v39
v_exp_f32 v40, v40
v_exp_f32 v41, v41
v_exp_f32 v42, v42
v_exp_f32 v43, v43
v_add_f32 v2, v28, v29
v_add_f32 v4, v30, v31
v_add_f32 v3, v36, v37
v_add_f32 v5, v38, v39
v_add_f32 v2, v2, v32
v_add_f32 v4, v4, v33
v_add_f32 v3, v3, v40
v_add_f32 v5, v5, v41
v_add_f32 v2, v2, v34
v_add_f32 v4, v4, v35
v_add_f32 v3, v3, v42
v_add_f32 v5, v5, v43
v_add_f32 v2, v2, v4
v_add_f32 v3, v3, v5
s_nop 0
s_nop 0
v_permlane32_swap_b32 v2, v3
s_nop 1
v_add_f32 v2, v2, v3
v_mov_b32 v3, v2
s_nop 1
v_permlane16_swap_b32 v2, v3
s_nop 1
v_add_f32 v2, v2, v3
v_rcp_f32 v2, v2
s_nop 0
v_mov_b32 v3, v2
s_nop 1
v_permlane32_swap_b32 v2, v3
s_nop 1
v_mul_f32 v28, v28, v2
v_mul_f32 v29, v29, v2
v_mul_f32 v30, v30, v2
v_mul_f32 v31, v31, v2
v_mul_f32 v32, v32, v2
v_mul_f32 v33, v33, v2
v_mul_f32 v34, v34, v2
v_mul_f32 v35, v35, v2
v_mul_f32 v36, v36, v3
v_mul_f32 v37, v37, v3
v_mul_f32 v38, v38, v3
v_mul_f32 v39, v39, v3
v_mul_f32 v40, v40, v3
v_mul_f32 v41, v41, v3
v_mul_f32 v42, v42, v3
v_mul_f32 v43, v43, v3
v_cvt_pk_bf16_f32 v44, v28, v29
v_cvt_pk_bf16_f32 v45, v30, v31
v_cvt_pk_bf16_f32 v46, v32, v33
v_cvt_pk_bf16_f32 v47, v34, v35
v_cvt_pk_bf16_f32 v48, v36, v37
v_cvt_pk_bf16_f32 v49, v38, v39
v_cvt_pk_bf16_f32 v50, v40, v41
v_cvt_pk_bf16_f32 v51, v42, v43
s_waitcnt lgkmcnt(0)
s_nop 0
v_mfma_f32_16x16x32_bf16 v[60:63], v[188:191], v[44:47], 0
v_mfma_f32_16x16x32_bf16 v[64:67], v[188:191], v[48:51], 0
v_mfma_f32_16x16x32_bf16 v[68:71], v[192:195], v[44:47], 0
v_mfma_f32_16x16x32_bf16 v[72:75], v[192:195], v[48:51], 0
v_mfma_f32_16x16x32_bf16 v[76:79], v[196:199], v[44:47], 0
v_mfma_f32_16x16x32_bf16 v[80:83], v[196:199], v[48:51], 0
v_mfma_f32_16x16x32_bf16 v[84:87], v[200:203], v[44:47], 0
v_mfma_f32_16x16x32_bf16 v[88:91], v[200:203], v[48:51], 0
v_mfma_f32_16x16x32_bf16 v[92:95], v[204:207], v[44:47], 0
v_mfma_f32_16x16x32_bf16 v[96:99], v[204:207], v[48:51], 0
v_mfma_f32_16x16x32_bf16 v[100:103], v[208:211], v[44:47], 0
v_mfma_f32_16x16x32_bf16 v[104:107], v[208:211], v[48:51], 0
v_mfma_f32_16x16x32_bf16 v[108:111], v[212:215], v[44:47], 0
v_mfma_f32_16x16x32_bf16 v[112:115], v[212:215], v[48:51], 0
v_mfma_f32_16x16x32_bf16 v[116:119], v[216:219], v[44:47], 0
v_mfma_f32_16x16x32_bf16 v[120:123], v[216:219], v[48:51], 0
s_mov_b32 s87, 50000
Lc0:
s_waitcnt vmcnt(0)
v_mul_lo_u32 v2, v12, s98
v_readlane_b32 s36, v12, s34
v_lshrrev_b32 v2, 28, v2
v_cmp_ne_u32 vcc, 4, v2
s_cbranch_vccz Lc1
buffer_load_dword v12, v14, s[68:71], s75 offen sc1
s_sub_u32 s87, s87, 1
s_cmp_lg_u32 s87, 0
s_cbranch_scc1 Lc0
Lc1:
s_cmp_eq_u32 s36, s97
s_cselect_b32 s99, 1, 0
s_cbranch_scc1 Los1
v_cvt_pk_bf16_f32 v124, v60, v61
v_cvt_pk_bf16_f32 v125, v62, v63
v_cvt_pk_bf16_f32 v126, v68, v69
v_cvt_pk_bf16_f32 v127, v70, v71
buffer_store_dwordx4 v[124:127], v6, s[60:63], s80 offen offset:0 sc1
v_cvt_pk_bf16_f32 v128, v64, v65
v_cvt_pk_bf16_f32 v129, v66, v67
v_cvt_pk_bf16_f32 v130, v72, v73
v_cvt_pk_bf16_f32 v131, v74, v75
buffer_store_dwordx4 v[128:131], v6, s[60:63], s80 offen offset:1024 sc1
v_cvt_pk_bf16_f32 v132, v76, v77
v_cvt_pk_bf16_f32 v133, v78, v79
v_cvt_pk_bf16_f32 v134, v84, v85
v_cvt_pk_bf16_f32 v135, v86, v87
buffer_store_dwordx4 v[132:135], v6, s[60:63], s80 offen offset:2048 sc1
v_cvt_pk_bf16_f32 v136, v80, v81
v_cvt_pk_bf16_f32 v137, v82, v83
v_cvt_pk_bf16_f32 v138, v88, v89
v_cvt_pk_bf16_f32 v139, v90, v91
buffer_store_dwordx4 v[136:139], v6, s[60:63], s80 offen offset:3072 sc1
v_cvt_pk_bf16_f32 v140, v92, v93
v_cvt_pk_bf16_f32 v141, v94, v95
v_cvt_pk_bf16_f32 v142, v100, v101
v_cvt_pk_bf16_f32 v143, v102, v103
buffer_store_dwordx4 v[140:143], v6, s[60:63], s94 offen offset:0 sc1
v_cvt_pk_bf16_f32 v144, v96, v97
v_cvt_pk_bf16_f32 v145, v98, v99
v_cvt_pk_bf16_f32 v146, v104, v105
v_cvt_pk_bf16_f32 v147, v106, v107
buffer_store_dwordx4 v[144:147], v6, s[60:63], s94 offen offset:1024 sc1
v_cvt_pk_bf16_f32 v148, v108, v109
v_cvt_pk_bf16_f32 v149, v110, v111
v_cvt_pk_bf16_f32 v150, v116, v117
v_cvt_pk_bf16_f32 v151, v118, v119
buffer_store_dwordx4 v[148:151], v6, s[60:63], s94 offen offset:2048 sc1
v_cvt_pk_bf16_f32 v152, v112, v113
v_cvt_pk_bf16_f32 v153, v114, v115
v_cvt_pk_bf16_f32 v154, v120, v121
v_cvt_pk_bf16_f32 v155, v122, v123
buffer_store_dwordx4 v[152:155], v6, s[60:63], s94 offen offset:3072 sc1
s_branch Los2
Los1:
v_cvt_pk_bf16_f32 v124, v60, v61
v_cvt_pk_bf16_f32 v125, v62, v63
v_cvt_pk_bf16_f32 v126, v68, v69
v_cvt_pk_bf16_f32 v127, v70, v71
buffer_store_dwordx4 v[124:127], v6, s[60:63], s80 offen offset:0
v_cvt_pk_bf16_f32 v128, v64, v65
v_cvt_pk_bf16_f32 v129, v66, v67
v_cvt_pk_bf16_f32 v130, v72, v73
v_cvt_pk_bf16_f32 v131, v74, v75
buffer_store_dwordx4 v[128:131], v6, s[60:63], s80 offen offset:1024
v_cvt_pk_bf16_f32 v132, v76, v77
v_cvt_pk_bf16_f32 v133, v78, v79
v_cvt_pk_bf16_f32 v134, v84, v85
v_cvt_pk_bf16_f32 v135, v86, v87
buffer_store_dwordx4 v[132:135], v6, s[60:63], s80 offen offset:2048
v_cvt_pk_bf16_f32 v136, v80, v81
v_cvt_pk_bf16_f32 v137, v82, v83
v_cvt_pk_bf16_f32 v138, v88, v89
v_cvt_pk_bf16_f32 v139, v90, v91
buffer_store_dwordx4 v[136:139], v6, s[60:63], s80 offen offset:3072
v_cvt_pk_bf16_f32 v140, v92, v93
v_cvt_pk_bf16_f32 v141, v94, v95
v_cvt_pk_bf16_f32 v142, v100, v101
v_cvt_pk_bf16_f32 v143, v102, v103
buffer_store_dwordx4 v[140:143], v6, s[60:63], s94 offen offset:0
v_cvt_pk_bf16_f32 v144, v96, v97
v_cvt_pk_bf16_f32 v145, v98, v99
v_cvt_pk_bf16_f32 v146, v104, v105
v_cvt_pk_bf16_f32 v147, v106, v107
buffer_store_dwordx4 v[144:147], v6, s[60:63], s94 offen offset:1024
v_cvt_pk_bf16_f32 v148, v108, v109
v_cvt_pk_bf16_f32 v149, v110, v111
v_cvt_pk_bf16_f32 v150, v116, v117
v_cvt_pk_bf16_f32 v151, v118, v119
buffer_store_dwordx4 v[148:151], v6, s[60:63], s94 offen offset:2048
v_cvt_pk_bf16_f32 v152, v112, v113
v_cvt_pk_bf16_f32 v153, v114, v115
v_cvt_pk_bf16_f32 v154, v120, v121
v_cvt_pk_bf16_f32 v155, v122, v123
buffer_store_dwordx4 v[152:155], v6, s[60:63], s94 offen offset:3072
Los2:
s_barrier
ds_read_b64_tr_b16 v[28:29], v16 offset:0
ds_read_b64_tr_b16 v[30:31], v16 offset:4096
ds_read_b64_tr_b16 v[32:33], v17 offset:0
ds_read_b64_tr_b16 v[34:35], v17 offset:4096
ds_read_b64_tr_b16 v[36:37], v18 offset:0
ds_read_b64_tr_b16 v[38:39], v18 offset:4096
ds_read_b64_tr_b16 v[40:41], v19 offset:0
ds_read_b64_tr_b16 v[42:43], v19 offset:4096
s_waitcnt lgkmcnt(6)
v_mfma_f32_16x16x32_bf16 v[60:63], v[28:31], v[124:127], 0
ds_read_b64_tr_b16 v[44:45], v20 offset:0
v_mfma_f32_16x16x32_bf16 v[64:67], v[28:31], v[128:131], 0
ds_read_b64_tr_b16 v[46:47], v20 offset:4096
s_waitcnt lgkmcnt(6)
v_mfma_f32_16x16x32_bf16 v[68:71], v[32:35], v[124:127], 0
ds_read_b64_tr_b16 v[48:49], v21 offset:0
v_mfma_f32_16x16x32_bf16 v[72:75], v[32:35], v[128:131], 0
ds_read_b64_tr_b16 v[50:51], v21 offset:4096
s_waitcnt lgkmcnt(6)
v_mfma_f32_16x16x32_bf16 v[76:79], v[36:39], v[124:127], 0
ds_read_b64_tr_b16 v[52:53], v22 offset:0
v_mfma_f32_16x16x32_bf16 v[80:83], v[36:39], v[128:131], 0
ds_read_b64_tr_b16 v[54:55], v22 offset:4096
s_waitcnt lgkmcnt(6)
v_mfma_f32_16x16x32_bf16 v[84:87], v[40:43], v[124:127], 0
ds_read_b64_tr_b16 v[56:57], v23 offset:0
v_mfma_f32_16x16x32_bf16 v[88:91], v[40:43], v[128:131], 0
ds_read_b64_tr_b16 v[58:59], v23 offset:4096
s_waitcnt lgkmcnt(6)
v_mfma_f32_16x16x32_bf16 v[92:95], v[44:47], v[124:127], 0
ds_read_b64_tr_b16 v[28:29], v16 offset:8192
v_mfma_f32_16x16x32_bf16 v[96:99], v[44:47], v[128:131], 0
ds_read_b64_tr_b16 v[30:31], v16 offset:12288
s_waitcnt lgkmcnt(6)
v_mfma_f32_16x16x32_bf16 v[100:103], v[48:51], v[124:127], 0
ds_read_b64_tr_b16 v[32:33], v17 offset:8192
v_mfma_f32_16x16x32_bf16 v[104:107], v[48:51], v[128:131], 0
ds_read_b64_tr_b16 v[34:35], v17 offset:12288
s_waitcnt lgkmcnt(6)
v_mfma_f32_16x16x32_bf16 v[108:111], v[52:55], v[124:127], 0
ds_read_b64_tr_b16 v[36:37], v18 offset:8192
v_mfma_f32_16x16x32_bf16 v[112:115], v[52:55], v[128:131], 0
ds_read_b64_tr_b16 v[38:39], v18 offset:12288
s_waitcnt lgkmcnt(6)
v_mfma_f32_16x16x32_bf16 v[116:119], v[56:59], v[124:127], 0
ds_read_b64_tr_b16 v[40:41], v19 offset:8192
v_mfma_f32_16x16x32_bf16 v[120:123], v[56:59], v[128:131], 0
ds_read_b64_tr_b16 v[42:43], v19 offset:12288
s_waitcnt lgkmcnt(6)
v_mfma_f32_16x16x32_bf16 v[60:63], v[28:31], v[132:135], v[60:63]
ds_read_b64_tr_b16 v[44:45], v20 offset:8192
v_mfma_f32_16x16x32_bf16 v[64:67], v[28:31], v[136:139], v[64:67]
ds_read_b64_tr_b16 v[46:47], v20 offset:12288
s_waitcnt lgkmcnt(6)
v_mfma_f32_16x16x32_bf16 v[68:71], v[32:35], v[132:135], v[68:71]
ds_read_b64_tr_b16 v[48:49], v21 offset:8192
v_mfma_f32_16x16x32_bf16 v[72:75], v[32:35], v[136:139], v[72:75]
ds_read_b64_tr_b16 v[50:51], v21 offset:12288
s_waitcnt lgkmcnt(6)
v_mfma_f32_16x16x32_bf16 v[76:79], v[36:39], v[132:135], v[76:79]
ds_read_b64_tr_b16 v[52:53], v22 offset:8192
v_mfma_f32_16x16x32_bf16 v[80:83], v[36:39], v[136:139], v[80:83]
ds_read_b64_tr_b16 v[54:55], v22 offset:12288
s_waitcnt lgkmcnt(6)
v_mfma_f32_16x16x32_bf16 v[84:87], v[40:43], v[132:135], v[84:87]
ds_read_b64_tr_b16 v[56:57], v23 offset:8192
v_mfma_f32_16x16x32_bf16 v[88:91], v[40:43], v[136:139], v[88:91]
ds_read_b64_tr_b16 v[58:59], v23 offset:12288
s_waitcnt lgkmcnt(6)
v_mfma_f32_16x16x32_bf16 v[92:95], v[44:47], v[132:135], v[92:95]
ds_read_b64_tr_b16 v[28:29], v16 offset:16384
v_mfma_f32_16x16x32_bf16 v[96:99], v[44:47], v[136:139], v[96:99]
ds_read_b64_tr_b16 v[30:31], v16 offset:20480
s_waitcnt lgkmcnt(6)
v_mfma_f32_16x16x32_bf16 v[100:103], v[48:51], v[132:135], v[100:103]
ds_read_b64_tr_b16 v[32:33], v17 offset:16384
v_mfma_f32_16x16x32_bf16 v[104:107], v[48:51], v[136:139], v[104:107]
ds_read_b64_tr_b16 v[34:35], v17 offset:20480
s_waitcnt lgkmcnt(6)
v_mfma_f32_16x16x32_bf16 v[108:111], v[52:55], v[132:135], v[108:111]
ds_read_b64_tr_b16 v[36:37], v18 offset:16384
v_mfma_f32_16x16x32_bf16 v[112:115], v[52:55], v[136:139], v[112:115]
ds_read_b64_tr_b16 v[38:39], v18 offset:20480
s_waitcnt lgkmcnt(6)
v_mfma_f32_16x16x32_bf16 v[116:119], v[56:59], v[132:135], v[116:119]
ds_read_b64_tr_b16 v[40:41], v19 offset:16384
v_mfma_f32_16x16x32_bf16 v[120:123], v[56:59], v[136:139], v[120:123]
ds_read_b64_tr_b16 v[42:43], v19 offset:20480
s_waitcnt vmcnt(0)
s_mov_b64 exec, 15
s_cmp_eq_u32 s99, 1
s_cbranch_scc1 Lf1
buffer_store_dword v11, v8, s[60:63], 0 offen sc1
s_branch Lf2
Lf1:
buffer_store_dword v11, v8, s[60:63], 0 offen
Lf2:
s_mov_b64 exec, -1
s_waitcnt lgkmcnt(6)
v_mfma_f32_16x16x32_bf16 v[60:63], v[28:31], v[140:143], v[60:63]
ds_read_b64_tr_b16 v[44:45], v20 offset:16384
v_mfma_f32_16x16x32_bf16 v[64:67], v[28:31], v[144:147], v[64:67]
ds_read_b64_tr_b16 v[46:47], v20 offset:20480
s_waitcnt lgkmcnt(6)
v_mfma_f32_16x16x32_bf16 v[68:71], v[32:35], v[140:143], v[68:71]
ds_read_b64_tr_b16 v[48:49], v21 offset:16384
v_mfma_f32_16x16x32_bf16 v[72:75], v[32:35], v[144:147], v[72:75]
ds_read_b64_tr_b16 v[50:51], v21 offset:20480
s_waitcnt lgkmcnt(6)
v_mfma_f32_16x16x32_bf16 v[76:79], v[36:39], v[140:143], v[76:79]
ds_read_b64_tr_b16 v[52:53], v22 offset:16384
v_mfma_f32_16x16x32_bf16 v[80:83], v[36:39], v[144:147], v[80:83]
ds_read_b64_tr_b16 v[54:55], v22 offset:20480
s_waitcnt lgkmcnt(6)
v_mfma_f32_16x16x32_bf16 v[84:87], v[40:43], v[140:143], v[84:87]
ds_read_b64_tr_b16 v[56:57], v23 offset:16384
v_mfma_f32_16x16x32_bf16 v[88:91], v[40:43], v[144:147], v[88:91]
ds_read_b64_tr_b16 v[58:59], v23 offset:20480
s_waitcnt lgkmcnt(6)
v_mfma_f32_16x16x32_bf16 v[92:95], v[44:47], v[140:143], v[92:95]
ds_read_b64_tr_b16 v[28:29], v16 offset:24576
v_mfma_f32_16x16x32_bf16 v[96:99], v[44:47], v[144:147], v[96:99]
ds_read_b64_tr_b16 v[30:31], v16 offset:28672
s_waitcnt lgkmcnt(6)
v_mfma_f32_16x16x32_bf16 v[100:103], v[48:51], v[140:143], v[100:103]
ds_read_b64_tr_b16 v[32:33], v17 offset:24576
v_mfma_f32_16x16x32_bf16 v[104:107], v[48:51], v[144:147], v[104:107]
ds_read_b64_tr_b16 v[34:35], v17 offset:28672
s_waitcnt lgkmcnt(6)
v_mfma_f32_16x16x32_bf16 v[108:111], v[52:55], v[140:143], v[108:111]
ds_read_b64_tr_b16 v[36:37], v18 offset:24576
v_mfma_f32_16x16x32_bf16 v[112:115], v[52:55], v[144:147], v[112:115]
ds_read_b64_tr_b16 v[38:39], v18 offset:28672
s_waitcnt lgkmcnt(6)
v_mfma_f32_16x16x32_bf16 v[116:119], v[56:59], v[140:143], v[116:119]
ds_read_b64_tr_b16 v[40:41], v19 offset:24576
v_mfma_f32_16x16x32_bf16 v[120:123], v[56:59], v[144:147], v[120:123]
ds_read_b64_tr_b16 v[42:43], v19 offset:28672
s_waitcnt lgkmcnt(6)
v_mfma_f32_16x16x32_bf16 v[60:63], v[28:31], v[148:151], v[60:63]
ds_read_b64_tr_b16 v[44:45], v20 offset:24576
v_mfma_f32_16x16x32_bf16 v[64:67], v[28:31], v[152:155], v[64:67]
ds_read_b64_tr_b16 v[46:47], v20 offset:28672
s_waitcnt lgkmcnt(6)
v_mfma_f32_16x16x32_bf16 v[68:71], v[32:35], v[148:151], v[68:71]
ds_read_b64_tr_b16 v[48:49], v21 offset:24576
v_mfma_f32_16x16x32_bf16 v[72:75], v[32:35], v[152:155], v[72:75]
ds_read_b64_tr_b16 v[50:51], v21 offset:28672
s_waitcnt lgkmcnt(6)
v_mfma_f32_16x16x32_bf16 v[76:79], v[36:39], v[148:151], v[76:79]
ds_read_b64_tr_b16 v[52:53], v22 offset:24576
v_mfma_f32_16x16x32_bf16 v[80:83], v[36:39], v[152:155], v[80:83]
ds_read_b64_tr_b16 v[54:55], v22 offset:28672
s_waitcnt lgkmcnt(6)
v_mfma_f32_16x16x32_bf16 v[84:87], v[40:43], v[148:151], v[84:87]
ds_read_b64_tr_b16 v[56:57], v23 offset:24576
v_mfma_f32_16x16x32_bf16 v[88:91], v[40:43], v[152:155], v[88:91]
ds_read_b64_tr_b16 v[58:59], v23 offset:28672
s_waitcnt lgkmcnt(6)
v_mfma_f32_16x16x32_bf16 v[92:95], v[44:47], v[148:151], v[92:95]
s_barrier
ds_read_b64_tr_b16 v[28:29], v16 offset:32768
v_mfma_f32_16x16x32_bf16 v[96:99], v[44:47], v[152:155], v[96:99]
ds_read_b64_tr_b16 v[30:31], v16 offset:36864
s_waitcnt lgkmcnt(6)
v_mfma_f32_16x16x32_bf16 v[100:103], v[48:51], v[148:151], v[100:103]
ds_read_b64_tr_b16 v[32:33], v17 offset:32768
v_mfma_f32_16x16x32_bf16 v[104:107], v[48:51], v[152:155], v[104:107]
ds_read_b64_tr_b16 v[34:35], v17 offset:36864
s_waitcnt lgkmcnt(6)
v_mfma_f32_16x16x32_bf16 v[108:111], v[52:55], v[148:151], v[108:111]
ds_read_b64_tr_b16 v[36:37], v18 offset:32768
v_mfma_f32_16x16x32_bf16 v[112:115], v[52:55], v[152:155], v[112:115]
ds_read_b64_tr_b16 v[38:39], v18 offset:36864
s_waitcnt lgkmcnt(6)
v_mfma_f32_16x16x32_bf16 v[116:119], v[56:59], v[148:151], v[116:119]
ds_read_b64_tr_b16 v[40:41], v19 offset:32768
v_mfma_f32_16x16x32_bf16 v[120:123], v[56:59], v[152:155], v[120:123]
ds_read_b64_tr_b16 v[42:43], v19 offset:36864
s_add_u32 s94, s84, 4096
s_mov_b32 s37, -2
s_mov_b32 s87, 50000
Lp0:
buffer_load_dword v13, v7, s[60:63], 0 offen offset:0 sc1
Lp2:
s_waitcnt vmcnt(0)
v_cmp_eq_u32 vcc, 1, v13
s_sub_u32 s87, s87, 1
s_cmp_eq_u32 s87, 0
s_cbranch_scc1 Lp1
s_and_b32 s36, vcc_lo, 0xf
s_cmp_lg_u32 s36, 0xf
s_cbranch_scc1 Lp0
Lp1:
s_mov_b32 s37, -2
buffer_load_dwordx4 v[156:159], v6, s[60:63], s81 offen offset:0 sc1
buffer_load_dwordx4 v[160:163], v6, s[60:63], s81 offen offset:1024 sc1
buffer_load_dwordx4 v[164:167], v6, s[60:63], s81 offen offset:2048 sc1
buffer_load_dwordx4 v[168:171], v6, s[60:63], s81 offen offset:3072 sc1
buffer_load_dwordx4 v[172:175], v6, s[60:63], s91 offen offset:0 sc1
buffer_load_dwordx4 v[176:179], v6, s[60:63], s91 offen offset:1024 sc1
buffer_load_dwordx4 v[180:183], v6, s[60:63], s91 offen offset:2048 sc1
buffer_load_dwordx4 v[184:187], v6, s[60:63], s91 offen offset:3072 sc1
s_waitcnt vmcnt(6)
s_waitcnt lgkmcnt(6)
v_mfma_f32_16x16x32_bf16 v[60:63], v[28:31], v[156:159], v[60:63]
ds_read_b64_tr_b16 v[44:45], v20 offset:32768
v_mfma_f32_16x16x32_bf16 v[64:67], v[28:31], v[160:163], v[64:67]
ds_read_b64_tr_b16 v[46:47], v20 offset:36864
buffer_load_dwordx4 v[188:191], v6, s[60:63], s82 offen offset:0 sc1
s_waitcnt lgkmcnt(6)
v_mfma_f32_16x16x32_bf16 v[68:71], v[32:35], v[156:159], v[68:71]
ds_read_b64_tr_b16 v[48:49], v21 offset:32768
v_mfma_f32_16x16x32_bf16 v[72:75], v[32:35], v[160:163], v[72:75]
ds_read_b64_tr_b16 v[50:51], v21 offset:36864
s_waitcnt lgkmcnt(6)
v_mfma_f32_16x16x32_bf16 v[76:79], v[36:39], v[156:159], v[76:79]
ds_read_b64_tr_b16 v[52:53], v22 offset:32768
v_mfma_f32_16x16x32_bf16 v[80:83], v[36:39], v[160:163], v[80:83]
ds_read_b64_tr_b16 v[54:55], v22 offset:36864
s_waitcnt lgkmcnt(6)
v_mfma_f32_16x16x32_bf16 v[84:87], v[40:43], v[156:159], v[84:87]
ds_read_b64_tr_b16 v[56:57], v23 offset:32768
v_mfma_f32_16x16x32_bf16 v[88:91], v[40:43], v[160:163], v[88:91]
ds_read_b64_tr_b16 v[58:59], v23 offset:36864
s_waitcnt lgkmcnt(6)
v_mfma_f32_16x16x32_bf16 v[92:95], v[44:47], v[156:159], v[92:95]
ds_read_b64_tr_b16 v[28:29], v16 offset:40960
v_mfma_f32_16x16x32_bf16 v[96:99], v[44:47], v[160:163], v[96:99]
ds_read_b64_tr_b16 v[30:31], v16 offset:45056
buffer_load_dwordx4 v[192:195], v6, s[60:63], s82 offen offset:1024 sc1
s_waitcnt lgkmcnt(6)
v_mfma_f32_16x16x32_bf16 v[100:103], v[48:51], v[156:159], v[100:103]
ds_read_b64_tr_b16 v[32:33], v17 offset:40960
v_mfma_f32_16x16x32_bf16 v[104:107], v[48:51], v[160:163], v[104:107]
ds_read_b64_tr_b16 v[34:35], v17 offset:45056
s_waitcnt lgkmcnt(6)
v_mfma_f32_16x16x32_bf16 v[108:111], v[52:55], v[156:159], v[108:111]
ds_read_b64_tr_b16 v[36:37], v18 offset:40960
v_mfma_f32_16x16x32_bf16 v[112:115], v[52:55], v[160:163], v[112:115]
ds_read_b64_tr_b16 v[38:39], v18 offset:45056
s_waitcnt lgkmcnt(6)
v_mfma_f32_16x16x32_bf16 v[116:119], v[56:59], v[156:159], v[116:119]
ds_read_b64_tr_b16 v[40:41], v19 offset:40960
v_mfma_f32_16x16x32_bf16 v[120:123], v[56:59], v[160:163], v[120:123]
ds_read_b64_tr_b16 v[42:43], v19 offset:45056
s_waitcnt vmcnt(6)
s_waitcnt lgkmcnt(6)
v_mfma_f32_16x16x32_bf16 v[60:63], v[28:31], v[164:167], v[60:63]
ds_read_b64_tr_b16 v[44:45], v20 offset:40960
v_mfma_f32_16x16x32_bf16 v[64:67], v[28:31], v[168:171], v[64:67]
ds_read_b64_tr_b16 v[46:47], v20 offset:45056
buffer_load_dwordx4 v[196:199], v6, s[60:63], s82 offen offset:2048 sc1
s_waitcnt lgkmcnt(6)
v_mfma_f32_16x16x32_bf16 v[68:71], v[32:35], v[164:167], v[68:71]
ds_read_b64_tr_b16 v[48:49], v21 offset:40960
v_mfma_f32_16x16x32_bf16 v[72:75], v[32:35], v[168:171], v[72:75]
ds_read_b64_tr_b16 v[50:51], v21 offset:45056
s_waitcnt lgkmcnt(6)
v_mfma_f32_16x16x32_bf16 v[76:79], v[36:39], v[164:167], v[76:79]
ds_read_b64_tr_b16 v[52:53], v22 offset:40960
v_mfma_f32_16x16x32_bf16 v[80:83], v[36:39], v[168:171], v[80:83]
ds_read_b64_tr_b16 v[54:55], v22 offset:45056
s_waitcnt lgkmcnt(6)
v_mfma_f32_16x16x32_bf16 v[84:87], v[40:43], v[164:167], v[84:87]
ds_read_b64_tr_b16 v[56:57], v23 offset:40960
v_mfma_f32_16x16x32_bf16 v[88:91], v[40:43], v[168:171], v[88:91]
ds_read_b64_tr_b16 v[58:59], v23 offset:45056
s_waitcnt lgkmcnt(6)
v_mfma_f32_16x16x32_bf16 v[92:95], v[44:47], v[164:167], v[92:95]
ds_read_b64_tr_b16 v[28:29], v16 offset:49152
v_mfma_f32_16x16x32_bf16 v[96:99], v[44:47], v[168:171], v[96:99]
ds_read_b64_tr_b16 v[30:31], v16 offset:53248
buffer_load_dwordx4 v[200:203], v6, s[60:63], s82 offen offset:3072 sc1
s_waitcnt lgkmcnt(6)
v_mfma_f32_16x16x32_bf16 v[100:103], v[48:51], v[164:167], v[100:103]
ds_read_b64_tr_b16 v[32:33], v17 offset:49152
v_mfma_f32_16x16x32_bf16 v[104:107], v[48:51], v[168:171], v[104:107]
ds_read_b64_tr_b16 v[34:35], v17 offset:53248
s_waitcnt lgkmcnt(6)
v_mfma_f32_16x16x32_bf16 v[108:111], v[52:55], v[164:167], v[108:111]
ds_read_b64_tr_b16 v[36:37], v18 offset:49152
v_mfma_f32_16x16x32_bf16 v[112:115], v[52:55], v[168:171], v[112:115]
ds_read_b64_tr_b16 v[38:39], v18 offset:53248
s_waitcnt lgkmcnt(6)
v_mfma_f32_16x16x32_bf16 v[116:119], v[56:59], v[164:167], v[116:119]
ds_read_b64_tr_b16 v[40:41], v19 offset:49152
v_mfma_f32_16x16x32_bf16 v[120:123], v[56:59], v[168:171], v[120:123]
ds_read_b64_tr_b16 v[42:43], v19 offset:53248
s_waitcnt vmcnt(6)
s_waitcnt lgkmcnt(6)
v_mfma_f32_16x16x32_bf16 v[60:63], v[28:31], v[172:175], v[60:63]
ds_read_b64_tr_b16 v[44:45], v20 offset:49152
v_mfma_f32_16x16x32_bf16 v[64:67], v[28:31], v[176:179], v[64:67]
ds_read_b64_tr_b16 v[46:47], v20 offset:53248
buffer_load_dwordx4 v[204:207], v6, s[60:63], s92 offen offset:0 sc1
s_waitcnt lgkmcnt(6)
v_mfma_f32_16x16x32_bf16 v[68:71], v[32:35], v[172:175], v[68:71]
ds_read_b64_tr_b16 v[48:49], v21 offset:49152
v_mfma_f32_16x16x32_bf16 v[72:75], v[32:35], v[176:179], v[72:75]
ds_read_b64_tr_b16 v[50:51], v21 offset:53248
s_waitcnt lgkmcnt(6)
v_mfma_f32_16x16x32_bf16 v[76:79], v[36:39], v[172:175], v[76:79]
ds_read_b64_tr_b16 v[52:53], v22 offset:49152
v_mfma_f32_16x16x32_bf16 v[80:83], v[36:39], v[176:179], v[80:83]
ds_read_b64_tr_b16 v[54:55], v22 offset:53248
s_waitcnt lgkmcnt(6)
v_mfma_f32_16x16x32_bf16 v[84:87], v[40:43], v[172:175], v[84:87]
ds_read_b64_tr_b16 v[56:57], v23 offset:49152
v_mfma_f32_16x16x32_bf16 v[88:91], v[40:43], v[176:179], v[88:91]
ds_read_b64_tr_b16 v[58:59], v23 offset:53248
s_waitcnt lgkmcnt(6)
v_mfma_f32_16x16x32_bf16 v[92:95], v[44:47], v[172:175], v[92:95]
ds_read_b64_tr_b16 v[28:29], v16 offset:57344
v_mfma_f32_16x16x32_bf16 v[96:99], v[44:47], v[176:179], v[96:99]
ds_read_b64_tr_b16 v[30:31], v16 offset:61440
buffer_load_dwordx4 v[208:211], v6, s[60:63], s92 offen offset:1024 sc1
s_waitcnt lgkmcnt(6)
v_mfma_f32_16x16x32_bf16 v[100:103], v[48:51], v[172:175], v[100:103]
ds_read_b64_tr_b16 v[32:33], v17 offset:57344
v_mfma_f32_16x16x32_bf16 v[104:107], v[48:51], v[176:179], v[104:107]
ds_read_b64_tr_b16 v[34:35], v17 offset:61440
s_waitcnt lgkmcnt(6)
v_mfma_f32_16x16x32_bf16 v[108:111], v[52:55], v[172:175], v[108:111]
ds_read_b64_tr_b16 v[36:37], v18 offset:57344
v_mfma_f32_16x16x32_bf16 v[112:115], v[52:55], v[176:179], v[112:115]
ds_read_b64_tr_b16 v[38:39], v18 offset:61440
s_waitcnt lgkmcnt(6)
v_mfma_f32_16x16x32_bf16 v[116:119], v[56:59], v[172:175], v[116:119]
ds_read_b64_tr_b16 v[40:41], v19 offset:57344
v_mfma_f32_16x16x32_bf16 v[120:123], v[56:59], v[176:179], v[120:123]
ds_read_b64_tr_b16 v[42:43], v19 offset:61440
s_waitcnt vmcnt(6)
s_waitcnt lgkmcnt(6)
v_mfma_f32_16x16x32_bf16 v[60:63], v[28:31], v[180:183], v[60:63]
ds_read_b64_tr_b16 v[44:45], v20 offset:57344
v_mfma_f32_16x16x32_bf16 v[64:67], v[28:31], v[184:187], v[64:67]
ds_read_b64_tr_b16 v[46:47], v20 offset:61440
buffer_load_dwordx4 v[212:215], v6, s[60:63], s92 offen offset:2048 sc1
s_waitcnt lgkmcnt(6)
v_mfma_f32_16x16x32_bf16 v[68:71], v[32:35], v[180:183], v[68:71]
ds_read_b64_tr_b16 v[48:49], v21 offset:57344
v_mfma_f32_16x16x32_bf16 v[72:75], v[32:35], v[184:187], v[72:75]
ds_read_b64_tr_b16 v[50:51], v21 offset:61440
s_waitcnt lgkmcnt(6)
v_mfma_f32_16x16x32_bf16 v[76:79], v[36:39], v[180:183], v[76:79]
ds_read_b64_tr_b16 v[52:53], v22 offset:57344
v_mfma_f32_16x16x32_bf16 v[80:83], v[36:39], v[184:187], v[80:83]
ds_read_b64_tr_b16 v[54:55], v22 offset:61440
s_waitcnt lgkmcnt(6)
v_mfma_f32_16x16x32_bf16 v[84:87], v[40:43], v[180:183], v[84:87]
ds_read_b64_tr_b16 v[56:57], v23 offset:57344
v_mfma_f32_16x16x32_bf16 v[88:91], v[40:43], v[184:187], v[88:91]
ds_read_b64_tr_b16 v[58:59], v23 offset:61440
s_waitcnt lgkmcnt(6)
v_mfma_f32_16x16x32_bf16 v[92:95], v[44:47], v[180:183], v[92:95]
s_barrier
ds_read_b64_tr_b16 v[28:29], v24 offset:0
v_mfma_f32_16x16x32_bf16 v[96:99], v[44:47], v[184:187], v[96:99]
ds_read_b64_tr_b16 v[30:31], v24 offset:4096
buffer_load_dwordx4 v[216:219], v6, s[60:63], s92 offen offset:3072 sc1
s_waitcnt lgkmcnt(6)
v_mfma_f32_16x16x32_bf16 v[100:103], v[48:51], v[180:183], v[100:103]
ds_read_b64_tr_b16 v[32:33], v25 offset:0
v_mfma_f32_16x16x32_bf16 v[104:107], v[48:51], v[184:187], v[104:107]
ds_read_b64_tr_b16 v[34:35], v25 offset:4096
s_waitcnt lgkmcnt(6)
v_mfma_f32_16x16x32_bf16 v[108:111], v[52:55], v[180:183], v[108:111]
ds_read_b64_tr_b16 v[36:37], v26 offset:0
v_mfma_f32_16x16x32_bf16 v[112:115], v[52:55], v[184:187], v[112:115]
ds_read_b64_tr_b16 v[38:39], v26 offset:4096
s_waitcnt lgkmcnt(6)
v_mfma_f32_16x16x32_bf16 v[116:119], v[56:59], v[180:183], v[116:119]
ds_read_b64_tr_b16 v[40:41], v27 offset:0
v_mfma_f32_16x16x32_bf16 v[120:123], v[56:59], v[184:187], v[120:123]
ds_read_b64_tr_b16 v[42:43], v27 offset:4096
s_waitcnt vmcnt(6)
s_waitcnt lgkmcnt(6)
v_mfma_f32_16x16x32_bf16 v[60:63], v[28:31], v[188:191], v[60:63]
ds_read_b64_tr_b16 v[44:45], v252 offset:0
v_mfma_f32_16x16x32_bf16 v[64:67], v[28:31], v[192:195], v[64:67]
ds_read_b64_tr_b16 v[46:47], v252 offset:4096
buffer_load_dwordx4 v[220:223], v6, s[60:63], s83 offen offset:0 sc1
s_waitcnt lgkmcnt(6)
v_mfma_f32_16x16x32_bf16 v[68:71], v[32:35], v[188:191], v[68:71]
ds_read_b64_tr_b16 v[48:49], v253 offset:0
v_mfma_f32_16x16x32_bf16 v[72:75], v[32:35], v[192:195], v[72:75]
ds_read_b64_tr_b16 v[50:51], v253 offset:4096
s_waitcnt lgkmcnt(6)
v_mfma_f32_16x16x32_bf16 v[76:79], v[36:39], v[188:191], v[76:79]
ds_read_b64_tr_b16 v[52:53], v254 offset:0
v_mfma_f32_16x16x32_bf16 v[80:83], v[36:39], v[192:195], v[80:83]
ds_read_b64_tr_b16 v[54:55], v254 offset:4096
s_waitcnt lgkmcnt(6)
v_mfma_f32_16x16x32_bf16 v[84:87], v[40:43], v[188:191], v[84:87]
ds_read_b64_tr_b16 v[56:57], v255 offset:0
v_mfma_f32_16x16x32_bf16 v[88:91], v[40:43], v[192:195], v[88:91]
ds_read_b64_tr_b16 v[58:59], v255 offset:4096
s_waitcnt lgkmcnt(6)
v_mfma_f32_16x16x32_bf16 v[92:95], v[44:47], v[188:191], v[92:95]
ds_read_b64_tr_b16 v[28:29], v24 offset:8192
v_mfma_f32_16x16x32_bf16 v[96:99], v[44:47], v[192:195], v[96:99]
ds_read_b64_tr_b16 v[30:31], v24 offset:12288
buffer_load_dwordx4 v[224:227], v6, s[60:63], s83 offen offset:1024 sc1
s_waitcnt lgkmcnt(6)
v_mfma_f32_16x16x32_bf16 v[100:103], v[48:51], v[188:191], v[100:103]
ds_read_b64_tr_b16 v[32:33], v25 offset:8192
v_mfma_f32_16x16x32_bf16 v[104:107], v[48:51], v[192:195], v[104:107]
ds_read_b64_tr_b16 v[34:35], v25 offset:12288
s_waitcnt lgkmcnt(6)
v_mfma_f32_16x16x32_bf16 v[108:111], v[52:55], v[188:191], v[108:111]
ds_read_b64_tr_b16 v[36:37], v26 offset:8192
v_mfma_f32_16x16x32_bf16 v[112:115], v[52:55], v[192:195], v[112:115]
ds_read_b64_tr_b16 v[38:39], v26 offset:12288
s_waitcnt lgkmcnt(6)
v_mfma_f32_16x16x32_bf16 v[116:119], v[56:59], v[188:191], v[116:119]
ds_read_b64_tr_b16 v[40:41], v27 offset:8192
v_mfma_f32_16x16x32_bf16 v[120:123], v[56:59], v[192:195], v[120:123]
ds_read_b64_tr_b16 v[42:43], v27 offset:12288
s_waitcnt vmcnt(6)
s_waitcnt lgkmcnt(6)
v_mfma_f32_16x16x32_bf16 v[60:63], v[28:31], v[196:199], v[60:63]
ds_read_b64_tr_b16 v[44:45], v252 offset:8192
v_mfma_f32_16x16x32_bf16 v[64:67], v[28:31], v[200:203], v[64:67]
ds_read_b64_tr_b16 v[46:47], v252 offset:12288
buffer_load_dwordx4 v[228:231], v6, s[60:63], s83 offen offset:2048 sc1
s_waitcnt lgkmcnt(6)
v_mfma_f32_16x16x32_bf16 v[68:71], v[32:35], v[196:199], v[68:71]
ds_read_b64_tr_b16 v[48:49], v253 offset:8192
v_mfma_f32_16x16x32_bf16 v[72:75], v[32:35], v[200:203], v[72:75]
ds_read_b64_tr_b16 v[50:51], v253 offset:12288
s_waitcnt lgkmcnt(6)
v_mfma_f32_16x16x32_bf16 v[76:79], v[36:39], v[196:199], v[76:79]
ds_read_b64_tr_b16 v[52:53], v254 offset:8192
v_mfma_f32_16x16x32_bf16 v[80:83], v[36:39], v[200:203], v[80:83]
ds_read_b64_tr_b16 v[54:55], v254 offset:12288
s_waitcnt lgkmcnt(6)
v_mfma_f32_16x16x32_bf16 v[84:87], v[40:43], v[196:199], v[84:87]
ds_read_b64_tr_b16 v[56:57], v255 offset:8192
v_mfma_f32_16x16x32_bf16 v[88:91], v[40:43], v[200:203], v[88:91]
ds_read_b64_tr_b16 v[58:59], v255 offset:12288
s_waitcnt lgkmcnt(6)
v_mfma_f32_16x16x32_bf16 v[92:95], v[44:47], v[196:199], v[92:95]
ds_read_b64_tr_b16 v[28:29], v24 offset:16384
v_mfma_f32_16x16x32_bf16 v[96:99], v[44:47], v[200:203], v[96:99]
ds_read_b64_tr_b16 v[30:31], v24 offset:20480
buffer_load_dwordx4 v[232:235], v6, s[60:63], s83 offen offset:3072 sc1
s_waitcnt lgkmcnt(6)
v_mfma_f32_16x16x32_bf16 v[100:103], v[48:51], v[196:199], v[100:103]
ds_read_b64_tr_b16 v[32:33], v25 offset:16384
v_mfma_f32_16x16x32_bf16 v[104:107], v[48:51], v[200:203], v[104:107]
ds_read_b64_tr_b16 v[34:35], v25 offset:20480
s_waitcnt lgkmcnt(6)
v_mfma_f32_16x16x32_bf16 v[108:111], v[52:55], v[196:199], v[108:111]
ds_read_b64_tr_b16 v[36:37], v26 offset:16384
v_mfma_f32_16x16x32_bf16 v[112:115], v[52:55], v[200:203], v[112:115]
ds_read_b64_tr_b16 v[38:39], v26 offset:20480
s_waitcnt lgkmcnt(6)
v_mfma_f32_16x16x32_bf16 v[116:119], v[56:59], v[196:199], v[116:119]
ds_read_b64_tr_b16 v[40:41], v27 offset:16384
v_mfma_f32_16x16x32_bf16 v[120:123], v[56:59], v[200:203], v[120:123]
ds_read_b64_tr_b16 v[42:43], v27 offset:20480
s_waitcnt vmcnt(6)
s_waitcnt lgkmcnt(6)
v_mfma_f32_16x16x32_bf16 v[60:63], v[28:31], v[204:207], v[60:63]
ds_read_b64_tr_b16 v[44:45], v252 offset:16384
v_mfma_f32_16x16x32_bf16 v[64:67], v[28:31], v[208:211], v[64:67]
ds_read_b64_tr_b16 v[46:47], v252 offset:20480
buffer_load_dwordx4 v[236:239], v6, s[60:63], s93 offen offset:0 sc1
s_waitcnt lgkmcnt(6)
v_mfma_f32_16x16x32_bf16 v[68:71], v[32:35], v[204:207], v[68:71]
ds_read_b64_tr_b16 v[48:49], v253 offset:16384
v_mfma_f32_16x16x32_bf16 v[72:75], v[32:35], v[208:211], v[72:75]
ds_read_b64_tr_b16 v[50:51], v253 offset:20480
s_waitcnt lgkmcnt(6)
v_mfma_f32_16x16x32_bf16 v[76:79], v[36:39], v[204:207], v[76:79]
ds_read_b64_tr_b16 v[52:53], v254 offset:16384
v_mfma_f32_16x16x32_bf16 v[80:83], v[36:39], v[208:211], v[80:83]
ds_read_b64_tr_b16 v[54:55], v254 offset:20480
s_waitcnt lgkmcnt(6)
v_mfma_f32_16x16x32_bf16 v[84:87], v[40:43], v[204:207], v[84:87]
ds_read_b64_tr_b16 v[56:57], v255 offset:16384
v_mfma_f32_16x16x32_bf16 v[88:91], v[40:43], v[208:211], v[88:91]
ds_read_b64_tr_b16 v[58:59], v255 offset:20480
s_waitcnt lgkmcnt(6)
v_mfma_f32_16x16x32_bf16 v[92:95], v[44:47], v[204:207], v[92:95]
ds_read_b64_tr_b16 v[28:29], v24 offset:24576
v_mfma_f32_16x16x32_bf16 v[96:99], v[44:47], v[208:211], v[96:99]
ds_read_b64_tr_b16 v[30:31], v24 offset:28672
buffer_load_dwordx4 v[240:243], v6, s[60:63], s93 offen offset:1024 sc1
s_waitcnt lgkmcnt(6)
v_mfma_f32_16x16x32_bf16 v[100:103], v[48:51], v[204:207], v[100:103]
ds_read_b64_tr_b16 v[32:33], v25 offset:24576
v_mfma_f32_16x16x32_bf16 v[104:107], v[48:51], v[208:211], v[104:107]
ds_read_b64_tr_b16 v[34:35], v25 offset:28672
s_waitcnt lgkmcnt(6)
v_mfma_f32_16x16x32_bf16 v[108:111], v[52:55], v[204:207], v[108:111]
ds_read_b64_tr_b16 v[36:37], v26 offset:24576
v_mfma_f32_16x16x32_bf16 v[112:115], v[52:55], v[208:211], v[112:115]
ds_read_b64_tr_b16 v[38:39], v26 offset:28672
s_waitcnt lgkmcnt(6)
v_mfma_f32_16x16x32_bf16 v[116:119], v[56:59], v[204:207], v[116:119]
ds_read_b64_tr_b16 v[40:41], v27 offset:24576
v_mfma_f32_16x16x32_bf16 v[120:123], v[56:59], v[208:211], v[120:123]
ds_read_b64_tr_b16 v[42:43], v27 offset:28672
s_waitcnt vmcnt(6)
s_waitcnt lgkmcnt(6)
v_mfma_f32_16x16x32_bf16 v[60:63], v[28:31], v[212:215], v[60:63]
ds_read_b64_tr_b16 v[44:45], v252 offset:24576
v_mfma_f32_16x16x32_bf16 v[64:67], v[28:31], v[216:219], v[64:67]
ds_read_b64_tr_b16 v[46:47], v252 offset:28672
buffer_load_dwordx4 v[244:247], v6, s[60:63], s93 offen offset:2048 sc1
s_waitcnt lgkmcnt(6)
v_mfma_f32_16x16x32_bf16 v[68:71], v[32:35], v[212:215], v[68:71]
ds_read_b64_tr_b16 v[48:49], v253 offset:24576
v_mfma_f32_16x16x32_bf16 v[72:75], v[32:35], v[216:219], v[72:75]
ds_read_b64_tr_b16 v[50:51], v253 offset:28672
s_waitcnt lgkmcnt(6)
v_mfma_f32_16x16x32_bf16 v[76:79], v[36:39], v[212:215], v[76:79]
ds_read_b64_tr_b16 v[52:53], v254 offset:24576
v_mfma_f32_16x16x32_bf16 v[80:83], v[36:39], v[216:219], v[80:83]
ds_read_b64_tr_b16 v[54:55], v254 offset:28672
s_waitcnt lgkmcnt(6)
v_mfma_f32_16x16x32_bf16 v[84:87], v[40:43], v[212:215], v[84:87]
ds_read_b64_tr_b16 v[56:57], v255 offset:24576
v_mfma_f32_16x16x32_bf16 v[88:91], v[40:43], v[216:219], v[88:91]
ds_read_b64_tr_b16 v[58:59], v255 offset:28672
s_waitcnt lgkmcnt(6)
v_mfma_f32_16x16x32_bf16 v[92:95], v[44:47], v[212:215], v[92:95]
ds_read_b64_tr_b16 v[28:29], v24 offset:32768
v_mfma_f32_16x16x32_bf16 v[96:99], v[44:47], v[216:219], v[96:99]
ds_read_b64_tr_b16 v[30:31], v24 offset:36864
buffer_load_dwordx4 v[248:251], v6, s[60:63], s93 offen offset:3072 sc1
s_waitcnt lgkmcnt(6)
v_mfma_f32_16x16x32_bf16 v[100:103], v[48:51], v[212:215], v[100:103]
ds_read_b64_tr_b16 v[32:33], v25 offset:32768
v_mfma_f32_16x16x32_bf16 v[104:107], v[48:51], v[216:219], v[104:107]
ds_read_b64_tr_b16 v[34:35], v25 offset:36864
s_waitcnt lgkmcnt(6)
v_mfma_f32_16x16x32_bf16 v[108:111], v[52:55], v[212:215], v[108:111]
ds_read_b64_tr_b16 v[36:37], v26 offset:32768
v_mfma_f32_16x16x32_bf16 v[112:115], v[52:55], v[216:219], v[112:115]
ds_read_b64_tr_b16 v[38:39], v26 offset:36864
s_waitcnt lgkmcnt(6)
v_mfma_f32_16x16x32_bf16 v[116:119], v[56:59], v[212:215], v[116:119]
ds_read_b64_tr_b16 v[40:41], v27 offset:32768
v_mfma_f32_16x16x32_bf16 v[120:123], v[56:59], v[216:219], v[120:123]
ds_read_b64_tr_b16 v[42:43], v27 offset:36864
s_waitcnt vmcnt(6)
s_waitcnt lgkmcnt(6)
v_mfma_f32_16x16x32_bf16 v[60:63], v[28:31], v[220:223], v[60:63]
ds_read_b64_tr_b16 v[44:45], v24 offset:40960
v_mfma_f32_16x16x32_bf16 v[64:67], v[28:31], v[224:227], v[64:67]
ds_read_b64_tr_b16 v[46:47], v24 offset:45056
s_waitcnt lgkmcnt(6)
v_mfma_f32_16x16x32_bf16 v[68:71], v[32:35], v[220:223], v[68:71]
ds_read_b64_tr_b16 v[48:49], v25 offset:40960
v_mfma_f32_16x16x32_bf16 v[72:75], v[32:35], v[224:227], v[72:75]
ds_read_b64_tr_b16 v[50:51], v25 offset:45056
s_waitcnt lgkmcnt(6)
v_mfma_f32_16x16x32_bf16 v[76:79], v[36:39], v[220:223], v[76:79]
ds_read_b64_tr_b16 v[52:53], v26 offset:40960
v_mfma_f32_16x16x32_bf16 v[80:83], v[36:39], v[224:227], v[80:83]
ds_read_b64_tr_b16 v[54:55], v26 offset:45056
s_waitcnt lgkmcnt(6)
v_mfma_f32_16x16x32_bf16 v[84:87], v[40:43], v[220:223], v[84:87]
ds_read_b64_tr_b16 v[56:57], v27 offset:40960
v_mfma_f32_16x16x32_bf16 v[88:91], v[40:43], v[224:227], v[88:91]
ds_read_b64_tr_b16 v[58:59], v27 offset:45056
s_waitcnt vmcnt(4)
s_waitcnt lgkmcnt(6)
v_mfma_f32_16x16x32_bf16 v[60:63], v[44:47], v[228:231], v[60:63]
ds_read_b64_tr_b16 v[28:29], v24 offset:49152
v_mfma_f32_16x16x32_bf16 v[64:67], v[44:47], v[232:235], v[64:67]
ds_read_b64_tr_b16 v[30:31], v24 offset:53248
s_waitcnt lgkmcnt(6)
v_mfma_f32_16x16x32_bf16 v[68:71], v[48:51], v[228:231], v[68:71]
ds_read_b64_tr_b16 v[32:33], v25 offset:49152
v_mfma_f32_16x16x32_bf16 v[72:75], v[48:51], v[232:235], v[72:75]
ds_read_b64_tr_b16 v[34:35], v25 offset:53248
s_waitcnt lgkmcnt(6)
v_mfma_f32_16x16x32_bf16 v[76:79], v[52:55], v[228:231], v[76:79]
ds_read_b64_tr_b16 v[36:37], v26 offset:49152
v_mfma_f32_16x16x32_bf16 v[80:83], v[52:55], v[232:235], v[80:83]
ds_read_b64_tr_b16 v[38:39], v26 offset:53248
s_waitcnt lgkmcnt(6)
v_mfma_f32_16x16x32_bf16 v[84:87], v[56:59], v[228:231], v[84:87]
ds_read_b64_tr_b16 v[40:41], v27 offset:49152
v_mfma_f32_16x16x32_bf16 v[88:91], v[56:59], v[232:235], v[88:91]
ds_read_b64_tr_b16 v[42:43], v27 offset:53248
s_waitcnt vmcnt(2)
s_waitcnt lgkmcnt(6)
v_mfma_f32_16x16x32_bf16 v[60:63], v[28:31], v[236:239], v[60:63]
ds_read_b64_tr_b16 v[44:45], v24 offset:57344
v_mfma_f32_16x16x32_bf16 v[64:67], v[28:31], v[240:243], v[64:67]
ds_read_b64_tr_b16 v[46:47], v24 offset:61440
s_waitcnt lgkmcnt(6)
v_mfma_f32_16x16x32_bf16 v[68:71], v[32:35], v[236:239], v[68:71]
ds_read_b64_tr_b16 v[48:49], v25 offset:57344
v_mfma_f32_16x16x32_bf16 v[72:75], v[32:35], v[240:243], v[72:75]
ds_read_b64_tr_b16 v[50:51], v25 offset:61440
s_waitcnt lgkmcnt(6)
v_mfma_f32_16x16x32_bf16 v[76:79], v[36:39], v[236:239], v[76:79]
ds_read_b64_tr_b16 v[52:53], v26 offset:57344
v_mfma_f32_16x16x32_bf16 v[80:83], v[36:39], v[240:243], v[80:83]
ds_read_b64_tr_b16 v[54:55], v26 offset:61440
s_waitcnt lgkmcnt(6)
v_mfma_f32_16x16x32_bf16 v[84:87], v[40:43], v[236:239], v[84:87]
ds_read_b64_tr_b16 v[56:57], v27 offset:57344
v_mfma_f32_16x16x32_bf16 v[88:91], v[40:43], v[240:243], v[88:91]
ds_read_b64_tr_b16 v[58:59], v27 offset:61440
s_waitcnt vmcnt(0)
s_waitcnt lgkmcnt(6)
v_mfma_f32_16x16x32_bf16 v[60:63], v[44:47], v[244:247], v[60:63]
ds_read_b64_tr_b16 v[28:29], v252 offset:32768
v_mfma_f32_16x16x32_bf16 v[64:67], v[44:47], v[248:251], v[64:67]
ds_read_b64_tr_b16 v[30:31], v252 offset:36864
s_waitcnt lgkmcnt(6)
v_mfma_f32_16x16x32_bf16 v[68:71], v[48:51], v[244:247], v[68:71]
ds_read_b64_tr_b16 v[32:33], v253 offset:32768
v_mfma_f32_16x16x32_bf16 v[72:75], v[48:51], v[248:251], v[72:75]
ds_read_b64_tr_b16 v[34:35], v253 offset:36864
s_waitcnt lgkmcnt(6)
v_mfma_f32_16x16x32_bf16 v[76:79], v[52:55], v[244:247], v[76:79]
ds_read_b64_tr_b16 v[36:37], v254 offset:32768
v_mfma_f32_16x16x32_bf16 v[80:83], v[52:55], v[248:251], v[80:83]
ds_read_b64_tr_b16 v[38:39], v254 offset:36864
s_waitcnt lgkmcnt(6)
v_mfma_f32_16x16x32_bf16 v[84:87], v[56:59], v[244:247], v[84:87]
ds_read_b64_tr_b16 v[40:41], v255 offset:32768
v_mfma_f32_16x16x32_bf16 v[88:91], v[56:59], v[248:251], v[88:91]
ds_read_b64_tr_b16 v[42:43], v255 offset:36864
s_waitcnt lgkmcnt(6)
v_mfma_f32_16x16x32_bf16 v[92:95], v[28:31], v[220:223], v[92:95]
ds_read_b64_tr_b16 v[44:45], v252 offset:40960
v_mfma_f32_16x16x32_bf16 v[96:99], v[28:31], v[224:227], v[96:99]
ds_read_b64_tr_b16 v[46:47], v252 offset:45056
s_waitcnt lgkmcnt(6)
v_mfma_f32_16x16x32_bf16 v[100:103], v[32:35], v[220:223], v[100:103]
ds_read_b64_tr_b16 v[48:49], v253 offset:40960
v_mfma_f32_16x16x32_bf16 v[104:107], v[32:35], v[224:227], v[104:107]
ds_read_b64_tr_b16 v[50:51], v253 offset:45056
s_waitcnt lgkmcnt(6)
v_mfma_f32_16x16x32_bf16 v[108:111], v[36:39], v[220:223], v[108:111]
ds_read_b64_tr_b16 v[52:53], v254 offset:40960
v_mfma_f32_16x16x32_bf16 v[112:115], v[36:39], v[224:227], v[112:115]
ds_read_b64_tr_b16 v[54:55], v254 offset:45056
v_cvt_pk_bf16_f32 v124, v60, v61
v_cvt_pk_bf16_f32 v125, v62, v63
s_waitcnt lgkmcnt(6)
v_mfma_f32_16x16x32_bf16 v[116:119], v[40:43], v[220:223], v[116:119]
ds_read_b64_tr_b16 v[56:57], v255 offset:40960
v_mfma_f32_16x16x32_bf16 v[120:123], v[40:43], v[224:227], v[120:123]
ds_read_b64_tr_b16 v[58:59], v255 offset:45056
v_cvt_pk_bf16_f32 v126, v68, v69
v_cvt_pk_bf16_f32 v127, v70, v71
buffer_store_dwordx4 v[124:127], v6, s[60:63], s84 offen offset:0 sc1
s_waitcnt lgkmcnt(6)
v_mfma_f32_16x16x32_bf16 v[92:95], v[44:47], v[228:231], v[92:95]
ds_read_b64_tr_b16 v[28:29], v252 offset:49152
v_mfma_f32_16x16x32_bf16 v[96:99], v[44:47], v[232:235], v[96:99]
ds_read_b64_tr_b16 v[30:31], v252 offset:53248
v_cvt_pk_bf16_f32 v128, v64, v65
v_cvt_pk_bf16_f32 v129, v66, v67
s_waitcnt lgkmcnt(6)
v_mfma_f32_16x16x32_bf16 v[100:103], v[48:51], v[228:231], v[100:103]
ds_read_b64_tr_b16 v[32:33], v253 offset:49152
v_mfma_f32_16x16x32_bf16 v[104:107], v[48:51], v[232:235], v[104:107]
ds_read_b64_tr_b16 v[34:35], v253 offset:53248
v_cvt_pk_bf16_f32 v130, v72, v73
v_cvt_pk_bf16_f32 v131, v74, v75
buffer_store_dwordx4 v[128:131], v6, s[60:63], s84 offen offset:1024 sc1
s_waitcnt lgkmcnt(6)
v_mfma_f32_16x16x32_bf16 v[108:111], v[52:55], v[228:231], v[108:111]
ds_read_b64_tr_b16 v[36:37], v254 offset:49152
v_mfma_f32_16x16x32_bf16 v[112:115], v[52:55], v[232:235], v[112:115]
ds_read_b64_tr_b16 v[38:39], v254 offset:53248
v_cvt_pk_bf16_f32 v132, v76, v77
v_cvt_pk_bf16_f32 v133, v78, v79
s_waitcnt lgkmcnt(6)
v_mfma_f32_16x16x32_bf16 v[116:119], v[56:59], v[228:231], v[116:119]
ds_read_b64_tr_b16 v[40:41], v255 offset:49152
v_mfma_f32_16x16x32_bf16 v[120:123], v[56:59], v[232:235], v[120:123]
ds_read_b64_tr_b16 v[42:43], v255 offset:53248
v_cvt_pk_bf16_f32 v134, v84, v85
v_cvt_pk_bf16_f32 v135, v86, v87
buffer_store_dwordx4 v[132:135], v6, s[60:63], s84 offen offset:2048 sc1
s_waitcnt lgkmcnt(6)
v_mfma_f32_16x16x32_bf16 v[92:95], v[28:31], v[236:239], v[92:95]
ds_read_b64_tr_b16 v[44:45], v252 offset:57344
v_mfma_f32_16x16x32_bf16 v[96:99], v[28:31], v[240:243], v[96:99]
ds_read_b64_tr_b16 v[46:47], v252 offset:61440
v_cvt_pk_bf16_f32 v136, v80, v81
v_cvt_pk_bf16_f32 v137, v82, v83
s_waitcnt lgkmcnt(6)
v_mfma_f32_16x16x32_bf16 v[100:103], v[32:35], v[236:239], v[100:103]
ds_read_b64_tr_b16 v[48:49], v253 offset:57344
v_mfma_f32_16x16x32_bf16 v[104:107], v[32:35], v[240:243], v[104:107]
ds_read_b64_tr_b16 v[50:51], v253 offset:61440
v_cvt_pk_bf16_f32 v138, v88, v89
v_cvt_pk_bf16_f32 v139, v90, v91
buffer_store_dwordx4 v[136:139], v6, s[60:63], s84 offen offset:3072 sc1
s_waitcnt lgkmcnt(6)
v_mfma_f32_16x16x32_bf16 v[108:111], v[36:39], v[236:239], v[108:111]
ds_read_b64_tr_b16 v[52:53], v254 offset:57344
v_mfma_f32_16x16x32_bf16 v[112:115], v[36:39], v[240:243], v[112:115]
ds_read_b64_tr_b16 v[54:55], v254 offset:61440
s_waitcnt lgkmcnt(6)
v_mfma_f32_16x16x32_bf16 v[116:119], v[40:43], v[236:239], v[116:119]
ds_read_b64_tr_b16 v[56:57], v255 offset:57344
v_mfma_f32_16x16x32_bf16 v[120:123], v[40:43], v[240:243], v[120:123]
ds_read_b64_tr_b16 v[58:59], v255 offset:61440
s_waitcnt lgkmcnt(6)
v_mfma_f32_16x16x32_bf16 v[92:95], v[44:47], v[244:247], v[92:95]
v_mfma_f32_16x16x32_bf16 v[96:99], v[44:47], v[248:251], v[96:99]
s_waitcnt lgkmcnt(4)
v_mfma_f32_16x16x32_bf16 v[100:103], v[48:51], v[244:247], v[100:103]
v_mfma_f32_16x16x32_bf16 v[104:107], v[48:51], v[248:251], v[104:107]
s_waitcnt lgkmcnt(2)
v_mfma_f32_16x16x32_bf16 v[108:111], v[52:55], v[244:247], v[108:111]
v_mfma_f32_16x16x32_bf16 v[112:115], v[52:55], v[248:251], v[112:115]
s_waitcnt lgkmcnt(0)
v_mfma_f32_16x16x32_bf16 v[116:119], v[56:59], v[244:247], v[116:119]
v_mfma_f32_16x16x32_bf16 v[120:123], v[56:59], v[248:251], v[120:123]
s_nop 7
v_cvt_pk_bf16_f32 v140, v92, v93
v_cvt_pk_bf16_f32 v141, v94, v95
v_cvt_pk_bf16_f32 v142, v100, v101
v_cvt_pk_bf16_f32 v143, v102, v103
buffer_store_dwordx4 v[140:143], v6, s[60:63], s94 offen offset:0 sc1
v_cvt_pk_bf16_f32 v144, v96, v97
v_cvt_pk_bf16_f32 v145, v98, v99
v_cvt_pk_bf16_f32 v146, v104, v105
v_cvt_pk_bf16_f32 v147, v106, v107
buffer_store_dwordx4 v[144:147], v6, s[60:63], s94 offen offset:1024 sc1
v_cvt_pk_bf16_f32 v148, v108, v109
v_cvt_pk_bf16_f32 v149, v110, v111
v_cvt_pk_bf16_f32 v150, v116, v117
v_cvt_pk_bf16_f32 v151, v118, v119
buffer_store_dwordx4 v[148:151], v6, s[60:63], s94 offen offset:2048 sc1
v_cvt_pk_bf16_f32 v152, v112, v113
v_cvt_pk_bf16_f32 v153, v114, v115
v_cvt_pk_bf16_f32 v154, v120, v121
v_cvt_pk_bf16_f32 v155, v122, v123
buffer_store_dwordx4 v[152:155], v6, s[60:63], s94 offen offset:3072 sc1
s_mov_b32 s36, 0xffff0000
s_waitcnt vmcnt(0)
s_mov_b64 exec, 0xff
buffer_store_dword v11, v9, s[60:63], 0 offen sc1
s_mov_b64 exec, -1
s_mov_b32 s87, 50000
Lq0:
buffer_load_dword v13, v7, s[60:63], 0 offen offset:128 sc1
Lq2:
s_waitcnt vmcnt(0)
v_cmp_eq_u32 vcc, 1, v13
s_sub_u32 s87, s87, 1
s_cmp_eq_u32 s87, 0
s_cbranch_scc1 Lq1
s_and_b32 s36, vcc_lo, 0xff
s_cmp_lg_u32 s36, 0xff
s_cbranch_scc1 Lq0
Lq1:
s_mov_b32 s36, 0xffff0000
s_mov_b32 s94, s85
buffer_load_dwordx4 v[156:159], v6, s[60:63], s94 offen sc1
s_add_u32 s94, s94, 32768
buffer_load_dwordx4 v[160:163], v6, s[60:63], s94 offen sc1
s_add_u32 s94, s94, 32768
buffer_load_dwordx4 v[164:167], v6, s[60:63], s94 offen sc1
s_add_u32 s94, s94, 32768
buffer_load_dwordx4 v[168:171], v6, s[60:63], s94 offen sc1
s_add_u32 s94, s94, 32768
buffer_load_dwordx4 v[172:175], v6, s[60:63], s94 offen sc1
s_add_u32 s94, s94, 32768
buffer_load_dwordx4 v[176:179], v6, s[60:63], s94 offen sc1
s_add_u32 s94, s94, 32768
buffer_load_dwordx4 v[180:183], v6, s[60:63], s94 offen sc1
s_add_u32 s94, s94, 32768
buffer_load_dwordx4 v[184:187], v6, s[60:63], s94 offen sc1
s_waitcnt vmcnt(7)
v_lshlrev_b32 v60, 16, v156
v_and_b32 v61, s36, v156
v_lshlrev_b32 v62, 16, v157
v_and_b32 v63, s36, v157
v_lshlrev_b32 v64, 16, v158
v_and_b32 v65, s36, v158
v_lshlrev_b32 v66, 16, v159
v_and_b32 v67, s36, v159
s_waitcnt vmcnt(6)
v_lshlrev_b32 v68, 16, v160
v_and_b32 v69, s36, v160
v_lshlrev_b32 v70, 16, v161
v_and_b32 v71, s36, v161
v_lshlrev_b32 v72, 16, v162
v_and_b32 v73, s36, v162
v_lshlrev_b32 v74, 16, v163
v_and_b32 v75, s36, v163
v_pk_add_f32 v[60:61], v[60:61], v[68:69]
v_pk_add_f32 v[62:63], v[62:63], v[70:71]
v_pk_add_f32 v[64:65], v[64:65], v[72:73]
v_pk_add_f32 v[66:67], v[66:67], v[74:75]
s_waitcnt vmcnt(5)
v_lshlrev_b32 v68, 16, v164
v_and_b32 v69, s36, v164
v_lshlrev_b32 v70, 16, v165
v_and_b32 v71, s36, v165
v_lshlrev_b32 v72, 16, v166
v_and_b32 v73, s36, v166
v_lshlrev_b32 v74, 16, v167
v_and_b32 v75, s36, v167
v_pk_add_f32 v[60:61], v[60:61], v[68:69]
v_pk_add_f32 v[62:63], v[62:63], v[70:71]
v_pk_add_f32 v[64:65], v[64:65], v[72:73]
v_pk_add_f32 v[66:67], v[66:67], v[74:75]
s_waitcnt vmcnt(4)
v_lshlrev_b32 v68, 16, v168
v_and_b32 v69, s36, v168
v_lshlrev_b32 v70, 16, v169
v_and_b32 v71, s36, v169
v_lshlrev_b32 v72, 16, v170
v_and_b32 v73, s36, v170
v_lshlrev_b32 v74, 16, v171
v_and_b32 v75, s36, v171
v_pk_add_f32 v[60:61], v[60:61], v[68:69]
v_pk_add_f32 v[62:63], v[62:63], v[70:71]
v_pk_add_f32 v[64:65], v[64:65], v[72:73]
v_pk_add_f32 v[66:67], v[66:67], v[74:75]
s_waitcnt vmcnt(3)
v_lshlrev_b32 v68, 16, v172
v_and_b32 v69, s36, v172
v_lshlrev_b32 v70, 16, v173
v_and_b32 v71, s36, v173
v_lshlrev_b32 v72, 16, v174
v_and_b32 v73, s36, v174
v_lshlrev_b32 v74, 16, v175
v_and_b32 v75, s36, v175
v_pk_add_f32 v[60:61], v[60:61], v[68:69]
v_pk_add_f32 v[62:63], v[62:63], v[70:71]
v_pk_add_f32 v[64:65], v[64:65], v[72:73]
v_pk_add_f32 v[66:67], v[66:67], v[74:75]
s_waitcnt vmcnt(2)
v_lshlrev_b32 v68, 16, v176
v_and_b32 v69, s36, v176
v_lshlrev_b32 v70, 16, v177
v_and_b32 v71, s36, v177
v_lshlrev_b32 v72, 16, v178
v_and_b32 v73, s36, v178
v_lshlrev_b32 v74, 16, v179
v_and_b32 v75, s36, v179
v_pk_add_f32 v[60:61], v[60:61], v[68:69]
v_pk_add_f32 v[62:63], v[62:63], v[70:71]
v_pk_add_f32 v[64:65], v[64:65], v[72:73]
v_pk_add_f32 v[66:67], v[66:67], v[74:75]
s_waitcnt vmcnt(1)
v_lshlrev_b32 v68, 16, v180
v_and_b32 v69, s36, v180
v_lshlrev_b32 v70, 16, v181
v_and_b32 v71, s36, v181
v_lshlrev_b32 v72, 16, v182
v_and_b32 v73, s36, v182
v_lshlrev_b32 v74, 16, v183
v_and_b32 v75, s36, v183
v_pk_add_f32 v[60:61], v[60:61], v[68:69]
v_pk_add_f32 v[62:63], v[62:63], v[70:71]
v_pk_add_f32 v[64:65], v[64:65], v[72:73]
v_pk_add_f32 v[66:67], v[66:67], v[74:75]
s_waitcnt vmcnt(0)
v_lshlrev_b32 v68, 16, v184
v_and_b32 v69, s36, v184
v_lshlrev_b32 v70, 16, v185
v_and_b32 v71, s36, v185
v_lshlrev_b32 v72, 16, v186
v_and_b32 v73, s36, v186
v_lshlrev_b32 v74, 16, v187
v_and_b32 v75, s36, v187
v_pk_add_f32 v[60:61], v[60:61], v[68:69]
v_pk_add_f32 v[62:63], v[62:63], v[70:71]
v_pk_add_f32 v[64:65], v[64:65], v[72:73]
v_pk_add_f32 v[66:67], v[66:67], v[74:75]
v_cvt_pk_bf16_f32 v76, v60, v61
v_cvt_pk_bf16_f32 v77, v62, v63
v_cvt_pk_bf16_f32 v78, v64, v65
v_cvt_pk_bf16_f32 v79, v66, v67
buffer_store_dwordx2 v[76:77], v10, s[64:67], 0 offen offset:0
buffer_store_dwordx2 v[78:79], v10, s[64:67], 0 offen offset:32
Lend:
s_endpgm
.section .rodata,"a"
.p2align 6
.amdhsa_kernel concat_heads__gqa_block_cached__mha_block_cached__near_ridge_kernel
  .amdhsa_next_free_vgpr 256
  .amdhsa_next_free_sgpr 102
  .amdhsa_accum_offset 256
  .amdhsa_group_segment_fixed_size 0
  .amdhsa_kernarg_size 104
  .amdhsa_user_sgpr_count 2
  .amdhsa_user_sgpr_kernarg_segment_ptr 1
  .amdhsa_system_sgpr_workgroup_id_x 1
.end_amdhsa_kernel
```
